```python
import torch

def _softmax(x, axis=-1):
    return torch.softmax(x, dim=axis)
def _gelu(x):
    return torch.nn.functional.gelu(x, approximate="tanh")
def _silu(x):
    return torch.nn.functional.silu(x)
def _sigmoid(x):
    return torch.sigmoid(x)
def _layernorm(x, axis=-1, eps=1e-5):
    m = x.mean(dim=axis, keepdim=True)
    v = x.var(dim=axis, keepdim=True, unbiased=False)
    return (x - m) / torch.sqrt(v + eps)
def _scatter_add(tgt, idx, src, axis=0):
    return tgt.clone().index_add_(axis, idx, src)
def _segment_sum(src, seg, n):
    out = torch.zeros((n,) + src.shape[1:], dtype=src.dtype)
    return out.index_add_(0, seg, src)
def _pad(x, pw):
    flat = tuple(v for pair in reversed(pw) for v in pair)
    return torch.nn.functional.pad(x, flat)

kernel_name = 'sequential_preLN__sliding_block_cached__glu_gated_swiglu__decode'

def setup_inputs():

    _w = (lambda a: (lambda t: t.to(torch.bfloat16) if t.is_floating_point() else t)(torch.as_tensor(a)))
    def _A_setup():
        B, Sq, D = 2, 1, 576
        Hq, Hkv, Sk, Dh = 32, 16, 8192, 128
        assert Hq % Hkv == 0, (Hq, Hkv)
        return {
            "x": _w((lambda *s: torch.randn(*s, dtype=torch.bfloat16) * 0.05)(B, Sq, D)),
            "k_cache": _w((lambda *s: torch.randn(*s, dtype=torch.bfloat16) * 1.6)(B, Hkv, Sk, Dh)),
            "v_cache": _w((lambda *s: torch.randn(*s, dtype=torch.bfloat16) * 0.8)(B, Hkv, Sk, Dh)),
            "wq": _w((lambda *s: torch.randn(*s, dtype=torch.bfloat16) * 1.6)(D, Hq * Dh) * (D ** -0.5)),
            "wo": _w((lambda *s: torch.randn(*s, dtype=torch.bfloat16) * 0.8)(Hq * Dh, D) * ((Hq * Dh) ** -0.5)),
        }
    _A_in = _A_setup()

    def _B_setup():
        B, S, D, F = 2, 1, 576, 4608
        return {
            "x": _w((lambda *s: torch.randn(*s, dtype=torch.bfloat16) * 0.05)(B, S, D)),
            "w1": _w((lambda *s: torch.randn(*s, dtype=torch.bfloat16) * 0.4)(D, F) * (2.0 / D) ** 0.5),
            "w3": _w((lambda *s: torch.randn(*s, dtype=torch.bfloat16) * 0.4)(D, F) * (2.0 / D) ** 0.5),
            "w2": _w((lambda *s: torch.randn(*s, dtype=torch.bfloat16) * 0.4)(F, D) * (2.0 / F) ** 0.5),
        }
    _B_in = _B_setup()

    return {
        "A_x": _A_in["x"],
        "A_k_cache": _A_in["k_cache"],
        "A_v_cache": _A_in["v_cache"],
        "A_wq": _A_in["wq"],
        "A_wo": _A_in["wo"],
        "B_x": _B_in["x"],
        "B_w1": _B_in["w1"],
        "B_w3": _B_in["w3"],
        "B_w2": _B_in["w2"],
    }

def reference(A_x, A_k_cache, A_v_cache, A_wq, A_wo, B_x, B_w1, B_w3, B_w2):
    def _A_ref(x, k_cache, v_cache, wq, wo):
        B, Sq, D = x.shape
        Hq, Dh = 32, 128
        Hkv, Sk = k_cache.shape[1], k_cache.shape[2]
        W = min(4096, max(256, Sk // 4))
        rep = Hq // Hkv
        q = (lambda x, *d: x.permute(*d))((x @ wq).reshape(B, Sq, Hq, Dh), 0, 2, 1, 3)
        k = (lambda x, n, axis: torch.repeat_interleave(x, n, dim=axis))(k_cache[:, :, Sk - W:, :], rep, axis=1)
        v = (lambda x, n, axis: torch.repeat_interleave(x, n, dim=axis))(v_cache[:, :, Sk - W:, :], rep, axis=1)
        scores = torch.einsum("bhqd,bhkd->bhqk", q, k) * (Dh ** -0.5)
        p = _softmax(scores, axis=-1)
        o = torch.einsum("bhqk,bhkd->bhqd", p, v)
        return (lambda x, *d: x.permute(*d))(o, 0, 2, 1, 3).reshape(B, Sq, Hq * Dh) @ wo

    def _B_ref(x, w1, w3, w2):
        gate = torch.einsum("bsd,df->bsf", x, w1)
        up = torch.einsum("bsd,df->bsf", x, w3)
        h = _silu(gate) * up
        out = torch.einsum("bsf,fd->bsd", h, w2)
        return out

    x = A_x
    h = x + _A_ref(_layernorm(x, axis=-1), A_k_cache, A_v_cache, A_wq, A_wo)
    h2 = h + _B_ref(_layernorm(h, axis=-1), B_w1, B_w3, B_w2)
    return h2
```

```asm
; @launch grid=(256,1,1) block=(640,1,1) lds=160768
.amdgcn_target "amdgcn-amd-amdhsa--gfx950"
.text
.globl sequential_preLN__sliding_block_cached__glu_gated_swiglu__decode_kernel
.p2align 8
.type sequential_preLN__sliding_block_cached__glu_gated_swiglu__decode_kernel,@function
sequential_preLN__sliding_block_cached__glu_gated_swiglu__decode_kernel:
    s_cmp_ge_u32 s2, 256
    s_cbranch_scc1 L_EXIT
    s_load_dwordx16 s[16:31], s[0:1], 0
    s_load_dwordx8 s[32:39], s[0:1], 64
    v_cmp_gt_u32 vcc, 128, v0
    s_getpc_b64 s[70:71]
L_PCREF:
    v_lshlrev_b32 v1, 7, v0
    s_cbranch_vccz L_NOPF
    v_min_u32 v1, L_CODE_END-L_PCREF-4, v1
    global_load_dword v167, v1, s[70:71]
L_NOPF:
    v_lshrrev_b32 v1, 6, v0
    v_and_b32 v0, 63, v0
    v_readfirstlane_b32 s12, v1
    s_and_b32 s4, s2, 7
    s_lshr_b32 s5, s2, 3
    s_lshr_b32 s11, s5, 4
    s_lshl_b32 s60, s4, 1
    s_add_u32 s60, s60, s11
    s_bfe_u32 s61, s5, 0x10003
    s_and_b32 s62, s5, 7
    s_mov_b32 s68, 0x00030003
    s_mov_b32 s69, 0x00030003
    v_mov_b32 v2, 0
    s_sub_u32 s3, s12, 2
    s_sub_u32 s11, 9, s12
    s_cmp_lt_u32 s12, 2
    s_cselect_b32 s3, s11, s3
    s_min_u32 s72, s3, 8
    s_cmp_eq_u32 s3, 8
    s_cbranch_scc1 L_COMM
    s_cmp_eq_u32 s3, 9
    s_cbranch_scc0 L_COMP
L_LOAD:
    s_setprio 3
    v_lshrrev_b32 v91, 3, v0
    v_mul_u32_u24 v91, 8192, v91
    v_bfe_u32 v92, v0, 4, 1
    v_lshlrev_b32 v92, 1, v92
    v_and_b32 v93, 7, v0
    v_xor_b32 v92, v92, v93
    v_lshl_add_u32 v80, v92, 4, v91
    v_xor_b32 v81, 64, v80
    v_add_u32 v81, 64512, v81
    v_add_u32 v82, 129024, v80
    v_add_u32 v83, 129024, v81
    v_lshrrev_b32 v91, 4, v0
    v_lshlrev_b32 v92, 1, v91
    v_and_b32 v93, 15, v0
    v_xor_b32 v92, v92, v93
    v_lshlrev_b32 v91, 8, v91
    v_lshl_add_u32 v84, v92, 4, v91
    v_xor_b32 v85, 128, v84
    s_lshr_b32 s11, s5, 3
    s_mul_i32 s64, s11, 1179648
    s_lshl_b32 s11, s4, 10
    s_add_u32 s64, s64, s11
    s_lshl_b32 s11, s62, 7
    s_add_u32 s64, s64, s11
    s_lshl_b32 s75, s61, 4
    s_add_u32 s75, s75, s60
    s_lshl_b32 s75, s75, 21
    s_lshl_b32 s11, s62, 16
    s_add_u32 s75, s75, s11
    s_add_u32 s75, s75, 1572864
    s_mul_i32 s73, s2, 0x2f
    s_lshr_b32 s11, s2, 4
    s_add_u32 s73, s73, s11
    s_and_b32 s73, s73, 15
    s_lshl_b32 s73, s73, 12
    s_or_b32 s73, s73, s75
    s_mov_b32 m0, 142336
    s_waitcnt lgkmcnt(0)
    s_mov_b32 s40, s22
    s_and_b32 s41, s23, 0xffff
    s_mov_b32 s42, 4718592
    s_mov_b32 s43, 0x20000
    s_mov_b32 s66, s64
    s_mov_b32 s64, s73
    s_mov_b32 m0, 142336
    s_nop 0
    buffer_load_dwordx4 v80, s[40:43], s66 offen nt lds
    buffer_load_dwordx4 v81, s[40:43], s66 offen offset:1024 nt lds
    buffer_load_dwordx4 v82, s[40:43], s66 offen offset:2048 nt lds
    buffer_load_dwordx4 v83, s[40:43], s66 offen offset:3072 nt lds
    s_mov_b32 m0, 146432
    s_add_u32 s66, s66, 262144
    buffer_load_dwordx4 v80, s[40:43], s66 offen nt lds
    buffer_load_dwordx4 v81, s[40:43], s66 offen offset:1024 nt lds
    buffer_load_dwordx4 v82, s[40:43], s66 offen offset:2048 nt lds
    buffer_load_dwordx4 v83, s[40:43], s66 offen offset:3072 nt lds
    s_mov_b32 m0, 150528
    s_add_u32 s66, s66, 262144
    buffer_load_dwordx4 v80, s[40:43], s66 offen nt lds
    buffer_load_dwordx4 v81, s[40:43], s66 offen offset:1024 nt lds
    buffer_load_dwordx4 v82, s[40:43], s66 offen offset:2048 nt lds
    buffer_load_dwordx4 v83, s[40:43], s66 offen offset:3072 nt lds
    s_mov_b32 m0, 154624
    s_add_u32 s66, s66, 262144
    buffer_load_dwordx4 v80, s[40:43], s66 offen nt lds
    buffer_load_dwordx4 v81, s[40:43], s66 offen offset:1024 nt lds
    buffer_load_dwordx4 v82, s[40:43], s66 offen offset:2048 nt lds
    buffer_load_dwordx4 v83, s[40:43], s66 offen offset:3072 nt lds
    s_mov_b32 m0, 158720
    s_add_u32 s66, s66, 262144
    buffer_load_dwordx4 v80, s[40:43], s66 offen nt lds
    buffer_load_dwordx4 v81, s[40:43], s66 offen offset:1024 nt lds
    s_mov_b32 s44, s18
    s_and_b32 s45, s19, 0xffff
    s_mov_b32 s46, 67108864
    s_mov_b32 s47, 0x20000
    s_mov_b32 m0, 76800
    s_nop 0
    buffer_load_dwordx4 v84, s[44:47], s64 offen nt lds
    buffer_load_dwordx4 v85, s[44:47], s64 offen offset:1024 nt lds
    buffer_load_dwordx4 v84, s[44:47], s64 offen offset:2048 nt lds
    buffer_load_dwordx4 v85, s[44:47], s64 offen offset:3072 nt lds
    s_mov_b32 s48, s20
    s_and_b32 s49, s21, 0xffff
    s_mov_b32 s50, 67108864
    s_mov_b32 s51, 0x20000
    s_mov_b32 s52, s38
    s_and_b32 s53, s39, 0xffff
    s_mov_b32 s54, 4194304
    s_mov_b32 s55, 0x20000
    s_load_dword s10, s[38:39], 0
    v_mov_b32 v90, 62
HOP_0:
HOPR_0:
    s_cbranch_execz HOP_1
    s_barrier
    s_branch L_LOAD2
L_COMM:
    s_setprio 2
    v_lshrrev_b32 v134, 5, v0
    v_mul_u32_u24 v134, 1152, v134
    v_and_b32 v135, 31, v0
    v_lshl_add_u32 v134, v135, 2, v134
    s_lshr_b32 s67, s5, 3
    s_mul_i32 s67, s67, 288
    v_lshlrev_b32 v132, 2, v0
    v_mov_b32 v133, 0x7f800000
    v_mov_b32 v135, 0x3f803f80
    s_waitcnt lgkmcnt(0)
    s_mov_b32 s40, s16
    s_and_b32 s41, s17, 0xffff
    s_mov_b32 s42, 2304
    s_mov_b32 s43, 0x20000
    buffer_load_dword v80, v134, s[40:43], 0 offen offset:0
    buffer_load_dword v81, v134, s[40:43], 0 offen offset:128
    buffer_load_dword v82, v134, s[40:43], 0 offen offset:256
    buffer_load_dword v83, v134, s[40:43], 0 offen offset:384
    buffer_load_dword v84, v134, s[40:43], 0 offen offset:512
    buffer_load_dword v85, v134, s[40:43], 0 offen offset:640
    buffer_load_dword v86, v134, s[40:43], 0 offen offset:768
    buffer_load_dword v87, v134, s[40:43], 0 offen offset:896
    buffer_load_dword v88, v134, s[40:43], 0 offen offset:1024
    buffer_load_dword v89, v134, s[40:43], s67 offen offset:0
    buffer_load_dword v90, v134, s[40:43], s67 offen offset:128
    buffer_load_dword v91, v134, s[40:43], s67 offen offset:256
    ds_write_b32 v132, v2
    ds_write_b32 v132, v2 offset:256
    s_mov_b64 exec, 0xffff
    ds_write_b32 v132, v133 offset:9984
    s_mov_b64 exec, -1
    s_mov_b32 s52, s38
    s_and_b32 s53, s39, 0xffff
    s_mov_b32 s54, 4194304
    s_mov_b32 s55, 0x20000
    s_waitcnt lgkmcnt(0)
    s_barrier
HOP_1:
    s_cbranch_execz HOP_2
    s_load_dword s10, s[38:39], 0
    ds_write_b32 v132, v135 offset:2816
    ds_write_b32 v132, v135 offset:3072
    ds_write_b32 v132, v135 offset:3328
    ds_write_b32 v132, v135 offset:3584
    ds_write_b32 v132, v135 offset:3840
    s_mul_i32 s74, s4, 18
    s_add_u32 s74, s74, s5
    s_sub_u32 s11, s5, 18
HOP_2:
    s_cbranch_execz HOP_3
    s_lshl_b32 s63, s11, 3
    s_add_u32 s63, s63, s4
    s_cmp_ge_u32 s5, 18
    s_cselect_b32 s74, s11, s74
    s_lshl_b32 s64, s63, 6
    s_min_u32 s64, s64, 0x10000
    v_lshlrev_b32 v136, 1, v0
    buffer_load_ushort v128, v136, s[40:43], s64 offen
    v_add_u32 v137, s67, v134
    v_mov_b32 v3, 0xff
    v_mov_b32 v7, 1
    v_mov_b32 v140, 0
HOP_3:
    s_cbranch_execz HOP_4
    v_lshlrev_b32 v149, 4, v0
    v_lshrrev_b32 v8, 4, v0
    v_lshlrev_b32 v4, 4, v8
    v_and_b32 v5, 1, v0
    v_bfe_u32 v9, v0, 2, 2
    v_lshl_add_u32 v10, v8, 3, v9
    v_lshlrev_b32 v10, 7, v10
    v_bfe_u32 v11, v0, 3, 1
    v_bfe_u32 v12, v0, 4, 1
    v_lshl_or_b32 v11, v12, 1, v11
HOP_4:
    s_cbranch_execz HOP_5
    v_lshlrev_b32 v11, 5, v11
    v_and_b32 v12, 3, v0
    v_lshl_or_b32 v11, v12, 3, v11
    v_add_u32 v6, v10, v11
    s_waitcnt vmcnt(4)
    v_lshlrev_b32 v16, 16, v80
    v_and_b32 v17, 0xffff0000, v80
    v_lshlrev_b32 v18, 16, v81
    v_and_b32 v19, 0xffff0000, v81
    v_lshlrev_b32 v20, 16, v82
    v_and_b32 v21, 0xffff0000, v82
HOP_5:
    s_cbranch_execz HOP_6
    v_lshlrev_b32 v22, 16, v83
    v_and_b32 v23, 0xffff0000, v83
    v_lshlrev_b32 v24, 16, v84
    v_and_b32 v25, 0xffff0000, v84
    v_lshlrev_b32 v26, 16, v85
    v_and_b32 v27, 0xffff0000, v85
    v_lshlrev_b32 v28, 16, v86
    v_and_b32 v29, 0xffff0000, v86
    v_lshlrev_b32 v30, 16, v87
    v_and_b32 v31, 0xffff0000, v87
HOP_6:
    s_cbranch_execz HOP_7
    v_lshlrev_b32 v32, 16, v88
    v_and_b32 v33, 0xffff0000, v88
    v_pk_add_f32 v[12:13], v[16:17], v[18:19]
    v_pk_add_f32 v[12:13], v[12:13], v[20:21]
    v_pk_add_f32 v[12:13], v[12:13], v[22:23]
    v_pk_add_f32 v[12:13], v[12:13], v[24:25]
    v_pk_add_f32 v[12:13], v[12:13], v[26:27]
    v_pk_add_f32 v[12:13], v[12:13], v[28:29]
HOP_7:
    s_cbranch_execz HOP_8
    v_pk_add_f32 v[12:13], v[12:13], v[30:31]
    v_pk_add_f32 v[12:13], v[12:13], v[32:33]
    v_add_f32 v8, v12, v13
    s_nop 1
    v_add_f32_dpp v8, v8, v8 quad_perm:[1,0,3,2] row_mask:0xf bank_mask:0xf
    s_nop 1
    v_add_f32_dpp v8, v8, v8 quad_perm:[2,3,0,1] row_mask:0xf bank_mask:0xf
    s_nop 1
    v_add_f32_dpp v8, v8, v8 row_half_mirror row_mask:0xf bank_mask:0xf
    s_nop 1
HOP_8:
    s_cbranch_execz HOP_9
    v_add_f32_dpp v8, v8, v8 row_mirror row_mask:0xf bank_mask:0xf
    v_mov_b32 v10, v8
    s_nop 1
    v_permlane16_swap_b32 v8, v10
    v_add_f32 v8, v8, v10
    v_mul_f32 v8, 0x3ae38e39, v8
    v_sub_f32 v16, v16, v8
    v_sub_f32 v17, v17, v8
    v_sub_f32 v18, v18, v8
    v_sub_f32 v19, v19, v8
    v_sub_f32 v20, v20, v8
    v_sub_f32 v21, v21, v8
    v_sub_f32 v22, v22, v8
HOP_9:
    s_cbranch_execz HOP_10
    v_sub_f32 v23, v23, v8
    v_sub_f32 v24, v24, v8
    v_sub_f32 v25, v25, v8
    v_sub_f32 v26, v26, v8
    v_sub_f32 v27, v27, v8
    v_sub_f32 v28, v28, v8
    v_sub_f32 v29, v29, v8
    v_sub_f32 v30, v30, v8
    v_sub_f32 v31, v31, v8
    v_sub_f32 v32, v32, v8
    v_sub_f32 v33, v33, v8
    v_pk_mul_f32 v[12:13], v[16:17], v[16:17]
    v_pk_fma_f32 v[12:13], v[18:19], v[18:19], v[12:13]
HOP_10:
    s_cbranch_execz HOP_11
    v_pk_fma_f32 v[12:13], v[20:21], v[20:21], v[12:13]
    v_pk_fma_f32 v[12:13], v[22:23], v[22:23], v[12:13]
    v_pk_fma_f32 v[12:13], v[24:25], v[24:25], v[12:13]
    v_pk_fma_f32 v[12:13], v[26:27], v[26:27], v[12:13]
    v_pk_fma_f32 v[12:13], v[28:29], v[28:29], v[12:13]
    v_pk_fma_f32 v[12:13], v[30:31], v[30:31], v[12:13]
    v_pk_fma_f32 v[12:13], v[32:33], v[32:33], v[12:13]
    v_add_f32 v9, v12, v13
HOP_11:
    s_cbranch_execz HOP_12
    s_nop 1
    v_add_f32_dpp v9, v9, v9 quad_perm:[1,0,3,2] row_mask:0xf bank_mask:0xf
    s_nop 1
    v_add_f32_dpp v9, v9, v9 quad_perm:[2,3,0,1] row_mask:0xf bank_mask:0xf
    s_nop 1
    v_add_f32_dpp v9, v9, v9 row_half_mirror row_mask:0xf bank_mask:0xf
    s_nop 1
    v_add_f32_dpp v9, v9, v9 row_mirror row_mask:0xf bank_mask:0xf
    v_mov_b32 v10, v9
    s_nop 1
    v_permlane16_swap_b32 v9, v10
HOP_12:
    s_cbranch_execz HOP_13
    v_add_f32 v9, v9, v10
    v_mul_f32 v9, 0x3ae38e39, v9
    v_cvt_pk_bf16_f32 v10, v8, v9
    v_and_b32 v9, 0xffff0000, v10
    v_lshlrev_b32 v8, 16, v10
    v_add_f32 v9, 0x3727c5ac, v9
    v_xor_b32 v8, 0x80000000, v8
    v_cvt_pk_bf16_f32 v9, v9, v9
    v_lshlrev_b32 v9, 16, v9
HOP_13:
    s_cbranch_execz HOP_14
    v_sqrt_f32 v9, v9
    s_nop 0
    v_cvt_pk_bf16_f32 v9, v9, v9
    v_lshlrev_b32 v9, 16, v9
    v_rcp_f32 v9, v9
    s_waitcnt vmcnt(1)
    v_lshlrev_b32 v16, 16, v89
    v_and_b32 v17, 0xffff0000, v89
    v_add_f32 v16, v16, v8
    v_add_f32 v17, v17, v8
    v_cvt_pk_bf16_f32 v89, v16, v17
    v_lshlrev_b32 v16, 16, v89
HOP_14:
    s_cbranch_execz HOP_15
    v_and_b32 v17, 0xffff0000, v89
    v_mul_f32 v16, v16, v9
    v_mul_f32 v17, v17, v9
    v_cvt_pk_bf16_f32 v89, v16, v17
    v_lshlrev_b32 v18, 16, v90
    v_and_b32 v19, 0xffff0000, v90
    v_add_f32 v18, v18, v8
    v_add_f32 v19, v19, v8
    v_cvt_pk_bf16_f32 v90, v18, v19
    v_lshlrev_b32 v18, 16, v90
HOP_15:
    s_cbranch_execz HOP_16
    v_and_b32 v19, 0xffff0000, v90
    v_mul_f32 v18, v18, v9
    v_mul_f32 v19, v19, v9
    v_cvt_pk_bf16_f32 v90, v18, v19
    v_lshlrev_b32 v20, 16, v91
    v_and_b32 v21, 0xffff0000, v91
    v_add_f32 v20, v20, v8
    v_add_f32 v21, v21, v8
    v_cvt_pk_bf16_f32 v91, v20, v21
    v_lshlrev_b32 v20, 16, v91
HOP_16:
    s_cbranch_execz HOP_17
    v_and_b32 v21, 0xffff0000, v91
    v_mul_f32 v20, v20, v9
    v_mul_f32 v21, v21, v9
    v_cvt_pk_bf16_f32 v91, v20, v21
    ds_write_b32 v137, v89 offset:512
    ds_write_b32 v137, v90 offset:640
    s_mov_b32 exec_lo, 0xff
    s_mov_b32 exec_hi, 0xff
HOP_17:
    s_cbranch_execz HOP_18
    ds_write_b32 v137, v91 offset:768
    s_mov_b64 exec, -1
    ds_write_b32 v2, v7 offset:4
    s_waitcnt vmcnt(0) lgkmcnt(0)
    s_add_u32 s76, s10, 1
    s_mul_i32 s76, s76, 0x9E3779B1
    s_and_b32 s6, s76, 0xff
    s_bfe_u32 s7, s76, 0x80008
    s_bfe_u32 s8, s76, 0x80010
HOP_18:
    s_cbranch_execz HOP_19
    s_lshr_b32 s9, s76, 24
    s_branch L_COMM2
L_LOAD2:
    s_mov_b32 m0, 80896
    s_add_u32 s64, s64, 4096
    s_and_b32 s64, s64, 0xffff
    s_or_b32 s64, s64, s75
    buffer_load_dwordx4 v84, s[44:47], s64 offen nt lds
    buffer_load_dwordx4 v85, s[44:47], s64 offen offset:1024 nt lds
    buffer_load_dwordx4 v84, s[44:47], s64 offen offset:2048 nt lds
HOP_19:
    s_cbranch_execz HOP_20
    buffer_load_dwordx4 v85, s[44:47], s64 offen offset:3072 nt lds
    v_add_u32 v90, 4, v90
    s_waitcnt vmcnt(24)
    ds_write_b32 v2, v90 offset:0
    s_mov_b32 m0, 84992
    s_add_u32 s64, s64, 4096
    s_and_b32 s64, s64, 0xffff
    s_or_b32 s64, s64, s75
    buffer_load_dwordx4 v84, s[44:47], s64 offen nt lds
HOP_20:
    s_cbranch_execz HOP_21
    buffer_load_dwordx4 v85, s[44:47], s64 offen offset:1024 nt lds
    buffer_load_dwordx4 v84, s[44:47], s64 offen offset:2048 nt lds
    buffer_load_dwordx4 v85, s[44:47], s64 offen offset:3072 nt lds
    v_add_u32 v90, 4, v90
    s_waitcnt vmcnt(24)
    ds_write_b32 v2, v90 offset:0
    s_mov_b32 m0, 89088
    s_add_u32 s64, s64, 4096
HOP_21:
    s_cbranch_execz HOP_22
    s_and_b32 s64, s64, 0xffff
    s_or_b32 s64, s64, s75
    buffer_load_dwordx4 v84, s[44:47], s64 offen nt lds
    buffer_load_dwordx4 v85, s[44:47], s64 offen offset:1024 nt lds
    buffer_load_dwordx4 v84, s[44:47], s64 offen offset:2048 nt lds
    buffer_load_dwordx4 v85, s[44:47], s64 offen offset:3072 nt lds
    v_add_u32 v90, 4, v90
    s_waitcnt vmcnt(24)
    ds_write_b32 v2, v90 offset:0
HOP_22:
    s_cbranch_execz HOP_23
    s_mov_b32 m0, 93184
    s_add_u32 s64, s64, 4096
    s_and_b32 s64, s64, 0xffff
    s_or_b32 s64, s64, s75
    buffer_load_dwordx4 v84, s[44:47], s64 offen nt lds
    buffer_load_dwordx4 v85, s[44:47], s64 offen offset:1024 nt lds
    buffer_load_dwordx4 v84, s[44:47], s64 offen offset:2048 nt lds
    buffer_load_dwordx4 v85, s[44:47], s64 offen offset:3072 nt lds
HOP_23:
    s_cbranch_execz HOP_24
    v_add_u32 v90, 4, v90
    s_waitcnt vmcnt(24)
    ds_write_b32 v2, v90 offset:0
    s_mov_b32 m0, 97280
    s_add_u32 s64, s64, 4096
    s_and_b32 s64, s64, 0xffff
    s_or_b32 s64, s64, s75
    v_mov_b32 v3, 0xff
    v_mov_b32 v7, 1
    v_mov_b32 v140, 0
HOP_24:
    s_cbranch_execz HOP_25
    v_lshlrev_b32 v149, 4, v0
    v_lshrrev_b32 v8, 4, v0
    v_lshlrev_b32 v4, 4, v8
    v_and_b32 v5, 1, v0
    v_bfe_u32 v9, v0, 2, 2
    v_lshl_add_u32 v10, v8, 3, v9
    v_lshlrev_b32 v10, 7, v10
    v_bfe_u32 v11, v0, 3, 1
    v_bfe_u32 v12, v0, 4, 1
    v_lshl_or_b32 v11, v12, 1, v11
HOP_25:
    s_cbranch_execz HOP_26
    v_lshlrev_b32 v11, 5, v11
    v_and_b32 v12, 3, v0
    v_lshl_or_b32 v11, v12, 3, v11
    v_add_u32 v6, v10, v11
    s_mul_i32 s74, s4, 18
    s_add_u32 s74, s74, s5
    s_sub_u32 s11, s5, 18
    s_lshl_b32 s63, s11, 3
    s_add_u32 s63, s63, s4
    s_cmp_ge_u32 s5, 18
    s_cselect_b32 s74, s11, s74
    v_lshrrev_b32 v91, 3, v0
    v_mul_u32_u24 v91, 1152, v91
HOP_26:
    s_cbranch_execz HOP_27
    v_bfe_u32 v92, v0, 4, 1
    v_lshlrev_b32 v92, 1, v92
    v_and_b32 v93, 7, v0
    v_xor_b32 v92, v92, v93
    v_lshl_add_u32 v80, v92, 4, v91
    v_xor_b32 v81, 64, v80
    v_add_u32 v81, 8192, v81
    v_add_u32 v82, 16384, v80
    v_add_u32 v83, 16384, v81
    v_lshlrev_b32 v94, 4, v0
HOP_27:
    s_cbranch_execz HOP_28
    v_lshrrev_b32 v91, 2, v0
    v_mul_u32_u24 v91, 9216, v91
    v_lshrrev_b32 v92, 5, v0
    v_lshlrev_b32 v92, 1, v92
    v_and_b32 v93, 3, v0
    v_xor_b32 v92, v92, v93
    v_lshl_add_u32 v86, v92, 4, v91
    v_add_u32 v87, 146432, v86
    v_add_u32 v88, 292864, v86
    v_add_u32 v89, 439296, v86
HOP_28:
    s_cbranch_execz L_RESUME
    s_mov_b32 s65, 4
ST_1:
    buffer_load_dwordx4 v84, s[44:47], s64 offen nt lds
    buffer_load_dwordx4 v85, s[44:47], s64 offen offset:1024 nt lds
    buffer_load_dwordx4 v84, s[44:47], s64 offen offset:2048 nt lds
    buffer_load_dwordx4 v85, s[44:47], s64 offen offset:3072 nt lds
    s_add_u32 s64, s64, 4096
    s_and_b32 s64, s64, 0xffff
    s_or_b32 s64, s64, s75
HOP_29:
HOPR_1:
    s_cbranch_execz HOP_30
    s_add_u32 m0, m0, 4096
    v_add_u32 v90, 4, v90
    s_waitcnt vmcnt(24)
    ds_write_b32 v2, v90 offset:0
    s_sub_u32 s65, s65, 1
    s_cmp_lg_u32 s65, 0
    s_cbranch_scc1 ST_1
    s_lshl_b32 s12, s72, 7
    s_add_u32 s12, s12, 7296
    v_mul_u32_u24 v9, 64, v5
    v_add3_u32 v9, v9, v4, s12
HOP_30:
    s_cbranch_execz HOP_31
    v_bfe_u32 v10, v0, 1, 3
    v_mov_b32 v11, 384
    v_cmp_eq_u32 vcc, 0, v10
    s_nop 1
    v_cndmask_b32 v141, v11, v9, vcc
    v_cmp_eq_u32 vcc, 1, v10
    s_nop 1
    v_cndmask_b32 v142, v11, v9, vcc
    v_cmp_eq_u32 vcc, 2, v10
    s_nop 1
    v_cndmask_b32 v143, v11, v9, vcc
    v_cmp_eq_u32 vcc, 3, v10
    s_nop 1
HOP_31:
    s_cbranch_execz HOP_32
    v_cndmask_b32 v144, v11, v9, vcc
    v_lshl_add_u32 v156, v0, 1, s12
    v_bfe_u32 v9, v0, 2, 1
    v_mad_u32_u24 v9, v5, 18, v9
    v_mul_u32_u24 v140, 18432, v9
    v_bfe_u32 v9, v0, 1, 1
    v_lshl_add_u32 v9, v9, 6, v4
    v_add_u32 v140, v140, v9
HOP_32:
    s_cbranch_execz HOP_33
    s_mul_i32 s36, s72, 36864
    s_lshl_b32 s11, s74, 7
    s_add_u32 s36, s36, s11
    s_add_u32 s36, s36, 1114112
    v_lshlrev_b32 v157, 2, v0
    v_and_b32 v158, 31, v0
    v_lshlrev_b32 v158, 2, v158
    v_lshrrev_b32 v159, 5, v0
    v_lshlrev_b32 v159, 3, v159
    s_lshl_b32 s12, s72, 12
    s_add_u32 s12, s12, 11264
    v_xor_b32 v145, 0, v6
HOP_33:
    s_cbranch_execz HOP_34
    v_xor_b32 v146, 32, v6
    v_xor_b32 v147, 64, v6
    v_xor_b32 v148, 96, v6
    v_add_u32 v145, s12, v145
    v_add_u32 v146, s12, v146
    v_add_u32 v147, s12, v147
    v_add_u32 v148, s12, v148
    s_mov_b32 s65, 7
ST_2:
    buffer_load_dwordx4 v84, s[44:47], s64 offen nt lds
    buffer_load_dwordx4 v85, s[44:47], s64 offen offset:1024 nt lds
    buffer_load_dwordx4 v84, s[44:47], s64 offen offset:2048 nt lds
HOP_34:
    s_cbranch_execz HOP_35
    buffer_load_dwordx4 v85, s[44:47], s64 offen offset:3072 nt lds
    s_add_u32 s64, s64, 4096
    s_and_b32 s64, s64, 0xffff
    s_or_b32 s64, s64, s75
    s_add_u32 m0, m0, 4096
    v_add_u32 v90, 4, v90
    s_waitcnt vmcnt(24)
    ds_write_b32 v2, v90 offset:0
    s_sub_u32 s65, s65, 1
    s_cmp_lg_u32 s65, 0
HOP_35:
    s_cbranch_execz HOP_36
    s_cbranch_scc1 ST_2
    s_mov_b32 m0, 11264
    s_mov_b32 s64, s73
    s_mov_b32 s40, s24
    s_and_b32 s41, s25, 0xffff
    s_mov_b32 s42, 4718592
    s_mov_b32 s43, 0x20000
    s_mov_b32 s65, 16
ST_3:
    buffer_load_dwordx4 v84, s[48:51], s64 offen nt lds
HOP_36:
    s_cbranch_execz HOP_37
    buffer_load_dwordx4 v85, s[48:51], s64 offen offset:1024 nt lds
    buffer_load_dwordx4 v84, s[48:51], s64 offen offset:2048 nt lds
    buffer_load_dwordx4 v85, s[48:51], s64 offen offset:3072 nt lds
    s_add_u32 s64, s64, 4096
    s_and_b32 s64, s64, 0xffff
    s_or_b32 s64, s64, s75
    s_add_u32 m0, m0, 4096
    v_add_u32 v90, 4, v90
    s_waitcnt vmcnt(24)
HOP_37:
    s_cbranch_execz HOP_38
    ds_write_b32 v2, v90 offset:0
    s_sub_u32 s65, s65, 1
    s_cmp_lg_u32 s65, 0
    s_cbranch_scc1 ST_3
    s_mov_b32 s15, 524288
PL_4:
    ds_read_b32 v91, v2 offset:12
    s_sub_u32 s15, s15, 1
    s_cbranch_scc1 PO_5
    s_waitcnt lgkmcnt(0)
    v_readfirstlane_b32 s11, v91
    s_cmp_lt_u32 s11, 8
    s_cbranch_scc1 PL_4
PO_5:
HOP_38:
    s_cbranch_execz HOP_39
    s_add_u32 s76, s10, 1
    s_mul_i32 s76, s76, 0x9E3779B1
    s_and_b32 s6, s76, 0xff
    s_bfe_u32 s7, s76, 0x80008
    s_bfe_u32 s8, s76, 0x80010
    s_lshr_b32 s9, s76, 24
    s_mov_b32 s70, s64
    s_mul_i32 s64, s4, 589824
    s_sub_u32 s11, s5, 18
    s_cmp_lt_u32 s11, 9
HOP_39:
    s_cbranch_execz HOP_40
    s_cbranch_scc1 L_LOADW
    s_add_u32 s67, s64, 147456
    s_mov_b32 s73, 0
    s_mov_b32 m0, 142336
    s_lshr_b32 s12, s74, 1
    s_and_b32 s12, s12, 7
    s_cmp_eq_u32 s12, 3
    s_cselect_b32 s73, 20, 0
    s_cmp_ge_u32 s5, 18
    s_cselect_b32 s73, 0, s73
    s_cmp_lg_u32 s73, 0
    s_cbranch_scc1 L_NOPFW
    s_sub_u32 s11, s5, 9
HOP_40:
    s_cbranch_execz HOP_41
    s_cmp_lt_u32 s5, 18
    s_cselect_b32 s14, s5, s11
    s_mul_i32 s11, s14, 5
    s_min_u32 s11, s11, 103
    s_lshl_b32 s11, s11, 12
    s_add_u32 s64, s67, s11
    s_mov_b32 s65, 5
ST_6:
    buffer_load_dwordx4 v94, s[40:43], s64 offen lds
    buffer_load_dwordx4 v94, s[40:43], s64 offen offset:1024 lds
    buffer_load_dwordx4 v94, s[40:43], s64 offen offset:2048 lds
HOP_41:
    s_cbranch_execz HOP_42
    buffer_load_dwordx4 v94, s[40:43], s64 offen offset:3072 lds
    s_add_u32 s64, s64, 4096
    v_add_u32 v90, 4, v90
    s_waitcnt vmcnt(24)
    ds_write_b32 v2, v90 offset:0
    s_sub_u32 s65, s65, 1
    s_cmp_lg_u32 s65, 0
    s_cbranch_scc1 ST_6
    s_cmp_lt_u32 s5, 27
    s_cbranch_scc1 L_NOPFW
    s_cmp_ge_u32 s5, 31
    s_cbranch_scc1 L_NOPFW
HOP_42:
    s_cbranch_execz HOP_43
    s_sub_u32 s12, 3, s4
    s_and_b32 s12, s12, 7
    s_lshl_b32 s11, s12, 1
    s_sub_u32 s13, s5, 27
    s_cmp_lt_u32 s13, 2
    s_cbranch_scc1 L_PFX
    s_cmp_lg_u32 s12, 0
    s_cbranch_scc1 L_NOPFW
    s_mov_b32 s11, 14
L_PFX:
    s_add_u32 s11, s11, s13
    s_mul_i32 s11, s11, 5
    s_lshl_b32 s11, s11, 12
    s_add_u32 s64, s67, s11
    s_mov_b32 s65, 5
ST_7:
HOP_43:
    s_cbranch_execz HOP_44
    buffer_load_dwordx4 v94, s[40:43], s64 offen lds
    buffer_load_dwordx4 v94, s[40:43], s64 offen offset:1024 lds
    buffer_load_dwordx4 v94, s[40:43], s64 offen offset:2048 lds
    buffer_load_dwordx4 v94, s[40:43], s64 offen offset:3072 lds
    s_add_u32 s64, s64, 4096
    v_add_u32 v90, 4, v90
    s_waitcnt vmcnt(24)
    ds_write_b32 v2, v90 offset:0
    s_sub_u32 s65, s65, 1
HOP_44:
    s_cbranch_execz HOP_45
    s_cmp_lg_u32 s65, 0
    s_cbranch_scc1 ST_7
L_NOPFW:
    s_mov_b32 m0, 76800
    s_mov_b32 s64, s70
    s_mov_b32 s48, s32
    s_and_b32 s49, s33, 0xffff
    s_mov_b32 s50, 5308416
    s_mov_b32 s51, 0x20000
    s_cmp_ge_u32 s5, 27
    s_cbranch_scc1 L_LOADH
    s_bitcmp1_b32 s5, 0
HOP_45:
    s_cbranch_execz HOP_46
    s_cselect_b32 s11, s30, s28
    s_cselect_b32 s12, s31, s29
    s_cselect_b32 s13, s28, s30
    s_cselect_b32 s14, s29, s31
    s_cselect_b32 s70, 36864, 0
    s_cselect_b32 s71, 0, 36864
    s_add_u32 s70, s70, 76800
    s_add_u32 s71, s71, 76800
    s_mov_b32 s40, s11
    s_and_b32 s41, s12, 0xffff
HOP_46:
    s_cbranch_execz HOP_47
    s_mov_b32 s42, 5308416
    s_mov_b32 s43, 0x20000
    s_mov_b32 s44, s13
    s_and_b32 s45, s14, 0xffff
    s_mov_b32 s46, 5308416
    s_mov_b32 s47, 0x20000
    v_add_u32 v90, 4, v90
    s_waitcnt vmcnt(20)
    ds_write_b32 v2, v90 offset:0
HOP_47:
    s_cbranch_execz HOP_48
    v_add_u32 v90, 4, v90
    s_waitcnt vmcnt(16)
    ds_write_b32 v2, v90 offset:0
    v_add_u32 v90, 4, v90
    s_waitcnt vmcnt(12)
    ds_write_b32 v2, v90 offset:0
    s_lshl_b32 s64, s74, 6
    s_mov_b32 m0, s70
    s_mov_b32 s65, 0
    s_mov_b32 s66, 0
L_FA:
    buffer_load_dwordx4 v86, s[40:43], s64 offen lds
HOP_48:
    s_cbranch_execz HOP_49
    buffer_load_dwordx4 v87, s[40:43], s64 offen offset:1024 lds
    buffer_load_dwordx4 v88, s[40:43], s64 offen offset:2048 lds
    buffer_load_dwordx4 v89, s[40:43], s64 offen offset:3072 lds
    ds_read_b32 v91, v2 offset:12
    s_add_u32 s64, s64, 589824
    s_add_u32 m0, m0, 4096
    s_add_u32 s65, s65, 1
    v_add_u32 v90, 4, v90
    s_cmp_lg_u32 s65, 9
HOP_49:
    s_cbranch_execz HOP_50
    s_cbranch_scc1 L_FA1
    s_mov_b32 s40, s44
    s_mov_b32 s41, s45
    s_lshl_b32 s64, s74, 6
    s_mov_b32 m0, s71
L_FA1:
    s_cmp_lg_u32 s66, 0
    s_cbranch_scc1 L_FA2
    s_waitcnt vmcnt(12) lgkmcnt(0)
    ds_write_b32 v2, v90 offset:0
    v_readfirstlane_b32 s11, v91
    s_cmp_lt_u32 s11, 16
    s_cbranch_scc1 L_FA3
    s_mov_b32 s66, 1
    v_subrev_u32 v90, 12, v90
HOP_50:
    s_cbranch_execz HOP_51
    v_add_u32 v90, s73, v90
    s_branch L_FA3
L_FA2:
    s_waitcnt vmcnt(24)
    ds_write_b32 v2, v90 offset:0
L_FA3:
    s_cmp_lt_u32 s65, 18
    s_cbranch_scc1 L_FA
    s_cmp_lg_u32 s66, 0
    s_cbranch_scc1 L_FA4
    s_mov_b32 s15, 524288
PL_8:
    ds_read_b32 v91, v2 offset:12
    s_sub_u32 s15, s15, 1
    s_cbranch_scc1 PO_9
HOP_51:
    s_cbranch_execz HOP_52
    s_waitcnt lgkmcnt(0)
    v_readfirstlane_b32 s11, v91
    s_cmp_lt_u32 s11, 16
    s_cbranch_scc1 PL_8
PO_9:
    v_subrev_u32 v90, 12, v90
    v_add_u32 v90, s73, v90
L_FA4:
    s_mul_i32 s64, s74, 36864
    s_mov_b32 m0, 11264
    s_mov_b32 s65, 6
ST_10:
    buffer_load_dwordx4 v80, s[48:51], s64 offen lds
    buffer_load_dwordx4 v81, s[48:51], s64 offen offset:1024 lds
HOP_52:
    s_cbranch_execz HOP_53
    buffer_load_dwordx4 v82, s[48:51], s64 offen offset:2048 lds
    buffer_load_dwordx4 v83, s[48:51], s64 offen offset:3072 lds
    s_add_u32 s64, s64, 128
    s_add_u32 m0, m0, 4096
    v_add_u32 v90, 4, v90
    s_waitcnt vmcnt(24)
    ds_write_b32 v2, v90 offset:0
    s_sub_u32 s65, s65, 1
    s_cmp_lg_u32 s65, 0
    s_cbranch_scc1 ST_10
HOP_53:
    s_cbranch_execz HOP_54
    buffer_load_dwordx4 v80, s[48:51], s64 offen lds
    buffer_load_dwordx4 v81, s[48:51], s64 offen offset:1024 lds
    buffer_load_dwordx4 v82, s[48:51], s64 offen offset:2048 lds
    buffer_load_dwordx4 v83, s[48:51], s64 offen offset:3072 lds
    s_add_u32 m0, m0, 4096
    s_add_u32 s64, s64, 128
    buffer_load_dwordx4 v80, s[48:51], s64 offen lds
HOP_54:
    s_cbranch_execz HOP_55
    buffer_load_dwordx4 v81, s[48:51], s64 offen offset:1024 lds
    buffer_load_dwordx4 v82, s[48:51], s64 offen offset:2048 lds
    buffer_load_dwordx4 v83, s[48:51], s64 offen offset:3072 lds
    s_add_u32 m0, m0, 4096
    s_add_u32 s64, s64, 128
    buffer_load_dwordx4 v80, s[48:51], s64 offen lds
    buffer_load_dwordx4 v81, s[48:51], s64 offen offset:1024 lds
HOP_55:
    s_cbranch_execz HOP_56
    buffer_load_dwordx4 v82, s[48:51], s64 offen offset:2048 lds
    buffer_load_dwordx4 v83, s[48:51], s64 offen offset:3072 lds
    s_add_u32 m0, m0, 4096
    s_add_u32 s64, s64, 128
    v_mov_b32 v90, 338
    s_waitcnt vmcnt(0)
    ds_write_b32 v2, v90 offset:0
    s_setprio 0
    s_branch L_F2
L_LOADH:
HOP_56:
    s_cbranch_execz HOP_57
    s_sub_u32 s11, s5, 27
    s_mul_i32 s11, s11, 33
    s_min_u32 s11, s11, 129
    s_lshl_b32 s11, s11, 12
    s_mul_i32 s64, s4, 663552
    s_add_u32 s64, s64, s11
    s_mov_b32 m0, 142336
    s_mov_b32 s65, 6
ST_11:
    buffer_load_dwordx4 v94, s[48:51], s64 offen lds
    buffer_load_dwordx4 v94, s[48:51], s64 offen offset:1024 lds
HOP_57:
    s_cbranch_execz L_RESUME
    buffer_load_dwordx4 v94, s[48:51], s64 offen offset:2048 lds
    buffer_load_dwordx4 v94, s[48:51], s64 offen offset:3072 lds
    s_add_u32 s64, s64, 4096
    v_add_u32 v90, 4, v90
    s_waitcnt vmcnt(24)
    ds_write_b32 v2, v90 offset:0
    s_sub_u32 s65, s65, 1
    s_cmp_lg_u32 s65, 0
    s_cbranch_scc1 ST_11
    s_mov_b32 s15, 524288
PL_12:
HOP_58:
HOPR_2:
    s_cbranch_execz HOP_59
    ds_read_b32 v91, v2 offset:12
    s_sub_u32 s15, s15, 1
    s_cbranch_scc1 PO_13
    s_waitcnt lgkmcnt(0)
    v_readfirstlane_b32 s11, v91
    s_cmp_lt_u32 s11, 16
    s_cbranch_scc1 PL_12
PO_13:
    s_mov_b32 s65, 27
L_HB:
    buffer_load_dwordx4 v94, s[48:51], s64 offen lds
    buffer_load_dwordx4 v94, s[48:51], s64 offen offset:1024 lds
    buffer_load_dwordx4 v94, s[48:51], s64 offen offset:2048 lds
HOP_59:
    s_cbranch_execz HOP_60
    buffer_load_dwordx4 v94, s[48:51], s64 offen offset:3072 lds
    s_add_u32 s64, s64, 4096
    s_waitcnt vmcnt(44)
    s_sub_u32 s65, s65, 1
    s_cmp_lg_u32 s65, 0
    s_cbranch_scc1 L_HB
    s_waitcnt vmcnt(0)
    s_waitcnt lgkmcnt(0)
    s_endpgm
L_LOADW:
    s_lshl_b32 s11, s74, 7
    s_add_u32 s64, s64, s11
    s_mov_b32 m0, 76800
HOP_60:
    s_cbranch_execz HOP_61
    v_subrev_u32 v90, 12, v90
    s_mov_b32 s65, 4
ST_14:
    buffer_load_dwordx4 v80, s[40:43], s64 offen lds
    buffer_load_dwordx4 v81, s[40:43], s64 offen offset:1024 lds
    buffer_load_dwordx4 v82, s[40:43], s64 offen offset:2048 lds
    buffer_load_dwordx4 v83, s[40:43], s64 offen offset:3072 lds
    s_add_u32 s64, s64, 36864
    s_add_u32 m0, m0, 4096
    v_add_u32 v90, 4, v90
HOP_61:
    s_cbranch_execz HOP_62
    s_waitcnt vmcnt(36)
    ds_write_b32 v2, v90 offset:0
    s_sub_u32 s65, s65, 1
    s_cmp_lg_u32 s65, 0
    s_cbranch_scc1 ST_14
    s_mov_b32 s71, s64
    s_mov_b32 m0, 76800
    s_mov_b32 s64, s70
    s_mov_b32 m0, 93184
    s_mov_b32 s64, s71
    s_mov_b32 s65, 12
ST_15:
HOP_62:
    s_cbranch_execz HOP_63
    buffer_load_dwordx4 v80, s[40:43], s64 offen lds
    buffer_load_dwordx4 v81, s[40:43], s64 offen offset:1024 lds
    buffer_load_dwordx4 v82, s[40:43], s64 offen offset:2048 lds
    buffer_load_dwordx4 v83, s[40:43], s64 offen offset:3072 lds
    s_add_u32 s64, s64, 36864
    s_add_u32 m0, m0, 4096
    v_add_u32 v90, 4, v90
    s_waitcnt vmcnt(36)
HOP_63:
    s_cbranch_execz HOP_64
    ds_write_b32 v2, v90 offset:0
    s_sub_u32 s65, s65, 1
    s_cmp_lg_u32 s65, 0
    s_cbranch_scc1 ST_15
    v_add_u32 v90, 4, v90
    s_waitcnt vmcnt(32)
    ds_write_b32 v2, v90 offset:0
    v_add_u32 v90, 4, v90
    s_waitcnt vmcnt(28)
    ds_write_b32 v2, v90 offset:0
    v_add_u32 v90, 4, v90
    s_waitcnt vmcnt(24)
HOP_64:
    s_cbranch_execz HOP_65
    ds_write_b32 v2, v90 offset:0
    v_add_u32 v90, 4, v90
    s_waitcnt vmcnt(20)
    ds_write_b32 v2, v90 offset:0
    v_add_u32 v90, 4, v90
    s_waitcnt vmcnt(16)
    ds_write_b32 v2, v90 offset:0
    v_add_u32 v90, 4, v90
    s_waitcnt vmcnt(12)
    ds_write_b32 v2, v90 offset:0
    v_add_u32 v90, 4, v90
HOP_65:
    s_cbranch_execz HOP_66
    s_waitcnt vmcnt(8)
    ds_write_b32 v2, v90 offset:0
    v_add_u32 v90, 4, v90
    s_waitcnt vmcnt(4)
    ds_write_b32 v2, v90 offset:0
    v_add_u32 v90, 4, v90
    s_waitcnt vmcnt(0)
    ds_write_b32 v2, v90 offset:0
    s_waitcnt lgkmcnt(0)
    s_endpgm
L_COMP:
    v_mov_b32 v3, 0xff
    v_mov_b32 v7, 1
    v_mov_b32 v140, 0
    v_lshlrev_b32 v149, 4, v0
    v_lshrrev_b32 v8, 4, v0
    v_lshlrev_b32 v4, 4, v8
    v_and_b32 v5, 1, v0
    v_bfe_u32 v9, v0, 2, 2
    v_lshl_add_u32 v10, v8, 3, v9
    v_lshlrev_b32 v10, 7, v10
    v_bfe_u32 v11, v0, 3, 1
    v_bfe_u32 v12, v0, 4, 1
    v_lshl_or_b32 v11, v12, 1, v11
    v_lshlrev_b32 v11, 5, v11
    v_and_b32 v12, 3, v0
    v_lshl_or_b32 v11, v12, 3, v11
    v_add_u32 v6, v10, v11
    s_mul_i32 s74, s4, 18
    s_add_u32 s74, s74, s5
    s_sub_u32 s11, s5, 18
    s_lshl_b32 s63, s11, 3
    s_add_u32 s63, s63, s4
    s_cmp_ge_u32 s5, 18
    s_cselect_b32 s74, s11, s74
    s_waitcnt lgkmcnt(0)
    s_mov_b32 s52, s38
    s_and_b32 s53, s39, 0xffff
    s_mov_b32 s54, 4194304
    s_mov_b32 s55, 0x20000
    s_load_dword s10, s[38:39], 0
    s_cmp_lg_u32 s3, 7
    s_cbranch_scc1 L_NOTOUCH
    v_lshlrev_b32 v116, 7, v0
    v_and_b32 v117, 0x1ff, v116
    s_lshr_b32 s11, s5, 4
    s_lshl_b32 s11, s11, 16
    s_lshl_b32 s12, s4, 13
    s_add_u32 s11, s11, s12
    s_and_b32 s12, s5, 15
    s_lshl_b32 s12, s12, 9
    s_add_u32 s11, s11, s12
    s_add_u32 s11, s11, 528384
    buffer_load_dword v120, v117, s[52:55], s11 offen
    v_and_b32 v118, 0x3ff, v116
    s_lshl_b32 s11, s4, 15
    s_lshl_b32 s12, s5, 10
    s_add_u32 s11, s11, s12
    s_add_u32 s11, s11, 667648
    buffer_load_dword v121, v118, s[52:55], s11 offen
    s_lshl_b32 s11, s4, 10
    s_add_u32 s11, s11, 659456
    buffer_load_dword v122, v118, s[52:55], s11 offen
    v_and_b32 v119, 0xff, v116
    s_lshl_b32 s11, s4, 13
    s_lshl_b32 s12, s5, 8
    s_add_u32 s11, s11, s12
    s_add_u32 s11, s11, 929792
    buffer_load_dword v123, v119, s[52:55], s11 offen
L_NOTOUCH:
    s_barrier
    s_mov_b64 exec, 0
    s_cmp_eq_u32 s3, 0
    s_cbranch_scc1 HOPR_0
    s_cmp_eq_u32 s3, 1
    s_cbranch_scc1 HOPR_1
    s_cmp_eq_u32 s3, 2
    s_cbranch_scc1 HOPR_2
    s_cmp_eq_u32 s3, 3
    s_cbranch_scc1 HOPR_3
    s_cmp_eq_u32 s3, 4
    s_cbranch_scc1 HOPR_4
    s_cmp_eq_u32 s3, 5
    s_cbranch_scc1 HOPR_5
    s_cmp_eq_u32 s3, 6
    s_cbranch_scc1 HOPR_6
    s_cmp_eq_u32 s3, 7
    s_cbranch_scc1 HOPR_7
L_RESUME:
    s_mov_b64 exec, -1
HOP_66:
    s_cbranch_execz HOP_67
    s_waitcnt lgkmcnt(0)
    s_add_u32 s76, s10, 1
    s_mul_i32 s76, s76, 0x9E3779B1
    s_and_b32 s6, s76, 0xff
    s_bfe_u32 s7, s76, 0x80008
    s_bfe_u32 s8, s76, 0x80010
    s_lshr_b32 s9, s76, 24
    s_cmp_ge_u32 s3, 4
    s_cbranch_scc1 L_NOQ
    s_lshl_b32 s11, s3, 5
    v_xor_b32 v12, s11, v6
HOP_67:
    s_cbranch_execz HOP_68
    v_add_u32 v12, 142336, v12
    v_lshrrev_b32 v9, 2, v0
    v_lshlrev_b32 v13, 7, v9
    v_bfe_u32 v10, v0, 3, 1
    v_bfe_u32 v11, v0, 5, 1
    v_lshl_or_b32 v10, v11, 1, v10
    v_lshlrev_b32 v10, 5, v10
    v_xor_b32 v10, s11, v10
    v_and_b32 v11, 3, v0
    v_lshl_or_b32 v10, v11, 3, v10
HOP_68:
    s_cbranch_execz HOP_69
    v_add_u32 v13, v13, v10
    v_add_u32 v13, 158720, v13
    s_lshr_b32 s12, s5, 3
    s_mul_i32 s12, s12, 288
    v_mul_u32_u24 v14, 1152, v5
    v_add3_u32 v14, v14, v4, s12
    v_add_u32 v14, 512, v14
    v_lshrrev_b32 v15, 1, v4
    v_sub_u32 v15, v14, v15
HOP_69:
    s_cbranch_execz HOP_70
    v_lshl_add_u32 v137, v5, 16, v4
    s_lshl_b32 s64, s4, 1
    s_lshr_b32 s12, s62, 2
    s_add_u32 s64, s64, s12
    s_lshl_b32 s64, s64, 2
    s_lshr_b32 s12, s5, 3
    s_add_u32 s64, s64, s12
    s_lshl_b32 s64, s64, 10
    s_and_b32 s12, s62, 3
    s_lshl_b32 s12, s12, 8
    s_add_u32 s64, s64, s12
    s_lshl_b32 s12, s3, 6
    s_add_u32 s64, s64, s12
HOP_70:
    s_cbranch_execz HOP_71
    s_add_u32 s64, s64, 4096
    s_mov_b32 s15, 524288
PL_16:
    ds_read_b32 v8, v2 offset:0
    s_sub_u32 s15, s15, 1
    s_cbranch_scc1 PO_17
    s_waitcnt lgkmcnt(0)
    v_readfirstlane_b32 s11, v8
    s_cmp_lt_u32 s11, 82
    s_cbranch_scc1 PL_16
PO_17:
    ds_read_b64_tr_b16 v[32:33], v13
HOP_71:
    s_cbranch_execz HOP_72
    ds_read_b64_tr_b16 v[16:17], v12 offset:0
    ds_read_b64_tr_b16 v[18:19], v12 offset:512
    ds_read_b64_tr_b16 v[20:21], v12 offset:4096
    ds_read_b64_tr_b16 v[22:23], v12 offset:4608
    ds_read_b64_tr_b16 v[24:25], v12 offset:8192
    ds_read_b64_tr_b16 v[26:27], v12 offset:8704
    ds_read_b64_tr_b16 v[28:29], v12 offset:12288
HOP_72:
    s_cbranch_execz HOP_73
    ds_read_b64_tr_b16 v[30:31], v12 offset:12800
    s_mov_b32 s15, 524288
PL_18:
    ds_read_b32 v8, v2 offset:4
    s_sub_u32 s15, s15, 1
    s_cbranch_scc1 PO_19
    s_waitcnt lgkmcnt(0)
    v_readfirstlane_b32 s11, v8
    s_cmp_lt_u32 s11, 1
    s_cbranch_scc1 PL_18
PO_19:
    ds_read_b64 v[96:97], v15 offset:256
HOP_73:
    s_cbranch_execz HOP_74
    ds_read_b128 v[80:83], v14 offset:0
    ds_read_b128 v[84:87], v14 offset:64
    ds_read_b128 v[88:91], v14 offset:128
    ds_read_b128 v[92:95], v14 offset:192
    s_waitcnt lgkmcnt(4)
    v_mfma_f32_16x16x16_bf16 v[120:123], v[32:33], v[96:97], 0
    s_waitcnt lgkmcnt(3)
    v_mfma_f32_16x16x32_bf16 v[116:119], v[16:19], v[80:83], 0
    s_waitcnt lgkmcnt(2)
HOP_74:
    s_cbranch_execz HOP_75
    v_mfma_f32_16x16x32_bf16 v[116:119], v[20:23], v[84:87], v[116:119]
    s_waitcnt lgkmcnt(1)
    v_mfma_f32_16x16x32_bf16 v[116:119], v[24:27], v[88:91], v[116:119]
    s_waitcnt lgkmcnt(0)
    v_mfma_f32_16x16x32_bf16 v[116:119], v[28:31], v[92:95], v[116:119]
    s_mov_b64 exec, s[68:69]
    s_nop 6
    v_add_f32 v116, v116, v120
    v_add_f32 v117, v117, v121
    v_add_f32 v118, v118, v122
    v_add_f32 v119, v119, v123
HOP_75:
    s_cbranch_execz HOP_76
    v_add_u32 v116, 0x80, v116
    v_add_u32 v117, 0x80, v117
    v_add_u32 v118, 0x80, v118
    v_add_u32 v119, 0x80, v119
    v_bfi_b32 v116, v3, s6, v116
    v_bfi_b32 v117, v3, s7, v117
    v_bfi_b32 v118, v3, s8, v118
HOP_76:
    s_cbranch_execz HOP_77
    v_bfi_b32 v119, v3, s9, v119
    s_add_u32 s11, s64, 524288
    buffer_store_dwordx4 v[116:119], v137, s[52:55], s11 offen
    buffer_store_dwordx4 v[116:119], v137, s[52:55], s64 offen sc1
    s_mov_b64 exec, -1
L_NOQ:
    s_cmp_ge_u32 s5, 27
    s_cbranch_scc1 L_SETUPD
    s_cmp_ge_u32 s5, 18
    s_cbranch_scc1 L_SETUPW
    v_bfe_u32 v153, v0, 2, 2
HOP_77:
    s_cbranch_execz HOP_78
    v_lshrrev_b32 v10, 1, v4
    v_add_u32 v153, v153, v10
    v_lshlrev_b32 v153, 6, v153
    v_bfe_u32 v10, v0, 4, 1
    v_lshlrev_b32 v10, 5, v10
    s_bfe_u32 s12, s3, 0x10001
    s_lshl_b32 s13, s12, 5
    v_xor_b32 v10, s13, v10
    v_and_b32 v11, 3, v0
    v_lshl_or_b32 v10, v11, 3, v10
    s_and_b32 s13, s3, 1
HOP_78:
    s_cbranch_execz HOP_79
    s_mul_i32 s64, s13, 36864
    s_lshr_b32 s14, s3, 2
    s_mul_i32 s65, s14, 18432
    s_add_u32 s64, s64, s65
    s_add_u32 s64, s64, 76800
    v_add3_u32 v153, v153, v10, s64
    v_mul_u32_u24 v154, 1152, v5
    v_add_u32 v154, 512, v154
HOP_79:
    s_cbranch_execz HOP_80
    v_mov_b32 v10, 2816
    v_and_b32 v11, 2, v0
    v_cmp_ne_u32 vcc, 0, v11
    s_mul_i32 s65, s14, 576
    s_lshl_b32 s13, s13, 1
    v_cndmask_b32 v154, v154, v10, vcc
    v_add3_u32 v154, v154, v4, s65
    s_add_u32 s13, s13, s14
    s_mul_i32 s13, s13, 384
    s_lshl_b32 s12, s12, 6
    s_add_u32 s13, s13, s12
HOP_80:
    s_cbranch_execz HOP_81
    v_and_b32 v11, 3, v0
    v_lshl_add_u32 v155, v11, 7, v4
    v_add_u32 v155, s13, v155
    s_lshl_b32 s12, s72, 7
    s_add_u32 s12, s12, 7296
    v_mul_u32_u24 v9, 64, v5
    v_add3_u32 v9, v9, v4, s12
    v_bfe_u32 v10, v0, 1, 3
    v_mov_b32 v11, 384
    v_cmp_eq_u32 vcc, 0, v10
HOP_81:
    s_cbranch_execz HOP_82
    s_nop 1
    v_cndmask_b32 v141, v11, v9, vcc
    v_cmp_eq_u32 vcc, 1, v10
    s_nop 1
    v_cndmask_b32 v142, v11, v9, vcc
    v_cmp_eq_u32 vcc, 2, v10
    s_nop 1
    v_cndmask_b32 v143, v11, v9, vcc
    v_cmp_eq_u32 vcc, 3, v10
    s_nop 1
    v_cndmask_b32 v144, v11, v9, vcc
    v_lshl_add_u32 v156, v0, 1, s12
    v_bfe_u32 v9, v0, 2, 1
HOP_82:
    s_cbranch_execz HOP_83
    v_mad_u32_u24 v9, v5, 18, v9
    v_mul_u32_u24 v140, 18432, v9
    v_bfe_u32 v9, v0, 1, 1
    v_lshl_add_u32 v9, v9, 6, v4
    v_add_u32 v140, v140, v9
    s_mul_i32 s36, s72, 36864
    s_lshl_b32 s11, s74, 7
    s_add_u32 s36, s36, s11
    s_add_u32 s36, s36, 1114112
HOP_83:
    s_cbranch_execz HOP_84
    v_lshlrev_b32 v157, 2, v0
    v_and_b32 v158, 31, v0
    v_lshlrev_b32 v158, 2, v158
    v_lshrrev_b32 v159, 5, v0
    v_lshlrev_b32 v159, 3, v159
    s_lshl_b32 s12, s72, 12
    s_add_u32 s12, s12, 11264
    v_xor_b32 v145, 0, v6
    v_xor_b32 v146, 32, v6
    v_xor_b32 v147, 64, v6
    v_xor_b32 v148, 96, v6
    v_add_u32 v145, s12, v145
    v_add_u32 v146, s12, v146
HOP_84:
    s_cbranch_execz HOP_85
    v_add_u32 v147, s12, v147
    v_add_u32 v148, s12, v148
    s_branch L_SETUPD
L_SETUPW:
    s_lshl_b32 s12, s3, 8
    s_add_u32 s12, s12, 5760
    v_mul_u32_u24 v9, 128, v5
    v_add3_u32 v9, v9, v4, s12
    v_bfe_u32 v10, v0, 1, 3
    v_mov_b32 v11, 384
    v_cmp_eq_u32 vcc, 0, v10
HOP_85:
    s_cbranch_execz HOP_86
    s_nop 1
    v_cndmask_b32 v141, v11, v9, vcc
    v_cmp_eq_u32 vcc, 1, v10
    s_nop 1
    v_cndmask_b32 v142, v11, v9, vcc
    v_cmp_eq_u32 vcc, 2, v10
    s_nop 1
    v_cndmask_b32 v143, v11, v9, vcc
    v_cmp_eq_u32 vcc, 3, v10
    s_nop 1
    v_cndmask_b32 v144, v11, v9, vcc
    v_lshrrev_b32 v150, 5, v0
    v_lshlrev_b32 v150, 7, v150
    v_and_b32 v9, 15, v0
HOP_86:
    s_cbranch_execz L_RESUME
    v_lshl_add_u32 v150, v9, 3, v150
    v_bfe_u32 v9, v0, 4, 1
    v_lshl_add_u32 v150, v9, 2, v150
    v_add_u32 v150, s12, v150
    v_bfe_u32 v151, v0, 1, 2
    v_lshl_add_u32 v151, v151, 6, v4
    v_lshl_add_u32 v151, v5, 8, v151
    s_lshl_b32 s12, s3, 9
HOP_87:
HOPR_3:
    s_cbranch_execz HOP_88
    s_add_u32 s12, s12, 142336
    v_add_u32 v151, s12, v151
    s_lshr_b32 s12, s3, 1
    s_lshl_b32 s12, s12, 6
    v_lshrrev_b32 v152, 2, v4
    v_add_u32 v152, s12, v152
    s_lshl_b32 s12, s3, 13
    s_add_u32 s12, s12, 76800
    v_xor_b32 v145, 0, v6
    v_xor_b32 v146, 32, v6
    v_xor_b32 v147, 64, v6
    v_xor_b32 v148, 96, v6
HOP_88:
    s_cbranch_execz HOP_89
    v_add_u32 v145, s12, v145
    v_add_u32 v146, s12, v146
    v_add_u32 v147, s12, v147
    v_add_u32 v148, s12, v148
    v_and_b32 v160, 7, v0
    v_lshlrev_b32 v160, 2, v160
    v_lshrrev_b32 v9, 4, v0
    v_add_u32 v160, v9, v160
    v_mul_u32_u24 v160, 48, v160
    s_lshl_b32 s11, s72, 2
    v_add_u32 v160, s11, v160
    s_mul_i32 s37, s63, 18432
    s_lshl_b32 s11, s72, 11
    s_add_u32 s37, s37, s11
HOP_89:
    s_cbranch_execz HOP_90
    s_add_u32 s37, s37, 1114112
    s_lshl_b32 s71, s4, 3
    s_add_u32 s71, s71, s3
    s_lshl_b32 s71, s71, 12
    s_add_u32 s71, s71, 143360
    s_add_u32 s70, s71, 524288
    s_lshl_b32 s36, s3, 3
    s_add_u32 s36, s36, 218
    s_cmp_lg_u32 s3, 0
    s_cbranch_scc1 L_SETUPD
    v_and_b32 v9, 31, v0
HOP_90:
    s_cbranch_execz HOP_91
    v_lshlrev_b32 v9, 7, v9
    s_lshl_b32 s11, s74, 12
    s_add_u32 s11, s11, 1048576
    buffer_load_dword v124, v9, s[52:55], s11 offen sc1
L_SETUPD:
    v_and_b32 v9, 15, v0
    v_lshlrev_b32 v10, 8, v9
    v_and_b32 v9, 7, v0
    v_lshlrev_b32 v9, 5, v9
    v_xor_b32 v9, v9, v4
    s_lshl_b32 s12, s3, 13
    s_add_u32 s12, s12, 76800
    v_add_u32 v10, s12, v10
HOP_91:
    s_cbranch_execz HOP_92
    v_xor_b32 v12, 0, v9
    v_xor_b32 v13, 64, v9
    v_xor_b32 v14, 128, v9
    v_xor_b32 v15, 192, v9
    v_add_u32 v12, v12, v10
    v_add_u32 v13, v13, v10
    v_add_u32 v14, v14, v10
    v_add_u32 v15, v15, v10
    v_lshl_add_u32 v132, v5, 8, v4
    v_lshlrev_b32 v139, 5, v5
    s_lshl_b32 s12, s3, 2
    v_add_u32 v133, s12, v139
HOP_92:
    s_cbranch_execz HOP_93
    v_lshrrev_b32 v134, 3, v4
    v_add_u32 v134, v134, v5
    v_mul_u32_u24 v134, 144, v134
    s_lshl_b32 s12, s3, 4
    v_add_u32 v135, s12, v134
    v_lshrrev_b32 v9, 2, v0
    v_lshlrev_b32 v136, 8, v9
    v_and_b32 v9, 7, v9
    v_lshlrev_b32 v9, 5, v9
    s_lshl_b32 s12, s3, 5
    v_xor_b32 v9, s12, v9
    v_and_b32 v11, 3, v0
    v_lshl_or_b32 v9, v11, 3, v9
HOP_93:
    s_cbranch_execz HOP_94
    v_add_u32 v136, v136, v9
    v_add_u32 v136, 11264, v136
    v_lshl_add_u32 v137, v5, 13, v4
    s_lshl_b32 s26, s60, 14
    s_lshr_b32 s12, s3, 2
    s_lshl_b32 s12, s12, 12
    s_add_u32 s26, s26, s12
    s_and_b32 s12, s5, 15
    s_lshl_b32 s12, s12, 8
    s_add_u32 s26, s26, s12
    s_and_b32 s12, s3, 3
    s_lshl_b32 s12, s12, 6
    s_add_u32 s26, s26, s12
HOP_94:
    s_cbranch_execz HOP_95
    s_add_u32 s26, s26, 667648
    s_lshl_b32 s12, s3, 6
    v_lshl_add_u32 v138, v5, 9, v4
    v_add_u32 v138, s12, v138
    s_sub_u32 s12, s5, 18
    s_cmp_lt_u32 s12, 9
    s_cselect_b32 s27, 16, 20
    s_lshl_b32 s13, s3, 3
    s_add_u32 s13, s13, 90
    s_mov_b32 s15, 524288
PL_20:
HOP_95:
    s_cbranch_execz HOP_96
    ds_read_b32 v8, v2 offset:0
    s_sub_u32 s15, s15, 1
    s_cbranch_scc1 PO_21
    s_waitcnt lgkmcnt(0)
    v_readfirstlane_b32 s11, v8
    s_cmp_ge_u32 s11, s13
    s_cbranch_scc1 PO_21
    s_sleep 1
    s_branch PL_20
PO_21:
    ds_read_b128 v[16:19], v12 offset:0
    ds_read_b128 v[20:23], v13 offset:0
HOP_96:
    s_cbranch_execz HOP_97
    ds_read_b128 v[24:27], v14 offset:0
    ds_read_b128 v[28:31], v15 offset:0
    ds_read_b128 v[32:35], v12 offset:4096
    ds_read_b128 v[36:39], v13 offset:4096
    ds_read_b128 v[40:43], v14 offset:4096
    ds_read_b128 v[44:47], v15 offset:4096
    s_mov_b32 s13, 0x3db504f3
HOP_97:
    s_cbranch_execz HOP_98
    s_mov_b32 s14, 0x3fb8aa3b
    s_waitcnt vmcnt(0) lgkmcnt(0)
    s_mov_b64 exec, 1
    ds_add_u32 v2, v7 offset:12
    s_mov_b64 exec, -1
    s_mov_b32 s15, 524288
PL_22:
    ds_read_b32 v8, v2 offset:8
    s_sub_u32 s15, s15, 1
    s_cbranch_scc1 PO_23
    s_waitcnt lgkmcnt(0)
    v_readfirstlane_b32 s11, v8
HOP_98:
    s_cbranch_execz HOP_99
    s_cmp_ge_u32 s11, 1
    s_cbranch_scc1 PO_23
    s_sleep 1
    s_branch PL_22
PO_23:
    ds_read_b128 v[80:83], v132 offset:4096
    ds_read_b128 v[84:87], v132 offset:4160
    ds_read_b128 v[88:91], v132 offset:4224
    ds_read_b128 v[92:95], v132 offset:4288
    s_waitcnt lgkmcnt(3)
    v_mfma_f32_16x16x32_bf16 v[116:119], v[16:19], v[80:83], 0
HOP_99:
    s_cbranch_execz HOP_100
    v_mfma_f32_16x16x32_bf16 v[120:123], v[32:35], v[80:83], 0
    s_waitcnt lgkmcnt(2)
    v_mfma_f32_16x16x32_bf16 v[116:119], v[20:23], v[84:87], v[116:119]
    v_mfma_f32_16x16x32_bf16 v[120:123], v[36:39], v[84:87], v[120:123]
    s_waitcnt lgkmcnt(1)
    v_mfma_f32_16x16x32_bf16 v[116:119], v[24:27], v[88:91], v[116:119]
    v_mfma_f32_16x16x32_bf16 v[120:123], v[40:43], v[88:91], v[120:123]
    s_waitcnt lgkmcnt(0)
    v_mfma_f32_16x16x32_bf16 v[116:119], v[28:31], v[92:95], v[116:119]
HOP_100:
    s_cbranch_execz HOP_101
    v_mfma_f32_16x16x32_bf16 v[120:123], v[44:47], v[92:95], v[120:123]
    s_nop 6
    v_cvt_pk_bf16_f32 v12, v116, v117
    v_lshlrev_b32 v116, 16, v12
    v_and_b32 v117, 0xffff0000, v12
    v_mul_f32 v116, s13, v116
    v_mul_f32 v117, s13, v117
    v_cvt_pk_bf16_f32 v12, v116, v117
    v_lshlrev_b32 v116, 16, v12
    v_and_b32 v117, 0xffff0000, v12
HOP_101:
    s_cbranch_execz HOP_102
    v_cvt_pk_bf16_f32 v12, v118, v119
    v_lshlrev_b32 v118, 16, v12
    v_and_b32 v119, 0xffff0000, v12
    v_mul_f32 v118, s13, v118
    v_mul_f32 v119, s13, v119
    v_cvt_pk_bf16_f32 v12, v118, v119
    v_lshlrev_b32 v118, 16, v12
    v_and_b32 v119, 0xffff0000, v12
    v_cvt_pk_bf16_f32 v12, v120, v121
    v_lshlrev_b32 v120, 16, v12
HOP_102:
    s_cbranch_execz HOP_103
    v_and_b32 v121, 0xffff0000, v12
    v_mul_f32 v120, s13, v120
    v_mul_f32 v121, s13, v121
    v_cvt_pk_bf16_f32 v12, v120, v121
    v_lshlrev_b32 v120, 16, v12
    v_and_b32 v121, 0xffff0000, v12
    v_cvt_pk_bf16_f32 v12, v122, v123
    v_lshlrev_b32 v122, 16, v12
    v_and_b32 v123, 0xffff0000, v12
    v_mul_f32 v122, s13, v122
HOP_103:
    s_cbranch_execz HOP_104
    v_mul_f32 v123, s13, v123
    v_cvt_pk_bf16_f32 v12, v122, v123
    v_lshlrev_b32 v122, 16, v12
    v_and_b32 v123, 0xffff0000, v12
    v_max3_f32 v12, v116, v117, v118
    v_max3_f32 v12, v12, v119, v120
    v_max3_f32 v12, v12, v121, v122
    v_max_f32 v12, v12, v123
    v_mov_b32 v13, v12
    s_nop 1
HOP_104:
    s_cbranch_execz HOP_105
    v_permlane32_swap_b32 v12, v13
    v_max_f32 v12, v12, v13
    v_mov_b32 v13, v12
    s_nop 1
    v_permlane16_swap_b32 v12, v13
    v_max_f32 v12, v12, v13
    s_mov_b64 exec, 3
    ds_write_b32 v133, v12 offset:9984
    s_mov_b64 exec, -1
    s_mov_b32 s15, 524288
L_MXP:
    ds_read_b128 v[80:83], v139 offset:9984
HOP_105:
    s_cbranch_execz HOP_106
    ds_read_b128 v[84:87], v139 offset:10000
    s_sub_u32 s15, s15, 1
    s_cbranch_scc1 L_MXD
    s_waitcnt lgkmcnt(1)
    v_max3_f32 v12, v80, v81, v82
    s_waitcnt lgkmcnt(0)
    v_max3_f32 v13, v83, v84, v85
    v_max3_f32 v12, v12, v86, v87
    v_max_f32 v12, v12, v13
    v_cmp_eq_u32 vcc, 0x7f800000, v12
HOP_106:
    s_cbranch_execz HOP_107
    s_cbranch_vccnz L_MXP
L_MXD:
    v_sub_f32 v116, v116, v12
    v_sub_f32 v117, v117, v12
    v_sub_f32 v118, v118, v12
    v_sub_f32 v119, v119, v12
    v_sub_f32 v120, v120, v12
    v_sub_f32 v121, v121, v12
    v_sub_f32 v122, v122, v12
    v_sub_f32 v123, v123, v12
    v_mul_f32 v116, s14, v116
    v_mul_f32 v117, s14, v117
    v_mul_f32 v118, s14, v118
    v_mul_f32 v119, s14, v119
    v_mul_f32 v120, s14, v120
    v_mul_f32 v121, s14, v121
HOP_107:
    s_cbranch_execz HOP_108
    v_mul_f32 v122, s14, v122
    v_mul_f32 v123, s14, v123
    v_exp_f32 v116, v116
    v_exp_f32 v117, v117
    v_exp_f32 v118, v118
    v_exp_f32 v119, v119
    v_exp_f32 v120, v120
    v_exp_f32 v121, v121
    v_exp_f32 v122, v122
    v_exp_f32 v123, v123
    s_nop 0
    v_cvt_pk_bf16_f32 v80, v116, v117
    v_cvt_pk_bf16_f32 v81, v118, v119
HOP_108:
    s_cbranch_execz HOP_109
    v_cvt_pk_bf16_f32 v82, v120, v121
    v_cvt_pk_bf16_f32 v83, v122, v123
    v_add_f32 v116, v116, v117
    v_add_f32 v118, v118, v119
    v_add_f32 v120, v120, v121
    v_add_f32 v122, v122, v123
    v_add_f32 v116, v116, v118
    v_add_f32 v120, v120, v122
    s_mov_b64 exec, s[68:69]
    ds_write_b128 v135, v[80:83] offset:4608
    s_mov_b64 exec, -1
    v_add_f32 v116, v116, v120
HOP_109:
    s_cbranch_execz HOP_110
    v_mov_b32 v117, v116
    s_nop 1
    v_permlane32_swap_b32 v116, v117
    v_add_f32 v116, v116, v117
    v_mov_b32 v117, v116
    s_nop 1
    v_permlane16_swap_b32 v116, v117
    v_add_f32 v116, v116, v117
    s_mov_b64 exec, 3
    ds_write_b32 v133, v116 offset:10048
    s_mov_b64 exec, 1
    ds_add_u32 v2, v7 offset:40
    s_mov_b64 exec, -1
HOP_110:
    s_cbranch_execz HOP_111
    s_mov_b32 s15, 524288
PL_24:
    ds_read_b32 v8, v2 offset:40
    s_sub_u32 s15, s15, 1
    s_cbranch_scc1 PO_25
    s_waitcnt lgkmcnt(0)
    v_readfirstlane_b32 s11, v8
    s_cmp_lt_u32 s11, 8
    s_cbranch_scc1 PL_24
PO_25:
    ds_read_b128 v[80:83], v134 offset:4608
    ds_read_b128 v[84:87], v134 offset:4624
HOP_111:
    s_cbranch_execz HOP_112
    ds_read_b128 v[88:91], v134 offset:4640
    ds_read_b128 v[92:95], v134 offset:4656
    ds_read_b128 v[96:99], v134 offset:4672
    ds_read_b128 v[100:103], v134 offset:4688
    ds_read_b128 v[104:107], v134 offset:4704
    ds_read_b128 v[108:111], v134 offset:4720
    s_mov_b32 s15, 524288
PL_26:
HOP_112:
    s_cbranch_execz HOP_113
    ds_read_b32 v8, v2 offset:0
    s_sub_u32 s15, s15, 1
    s_cbranch_scc1 PO_27
    s_waitcnt lgkmcnt(0)
    v_readfirstlane_b32 s11, v8
    s_cmp_ge_u32 s11, 178
    s_cbranch_scc1 PO_27
    s_sleep 1
    s_branch PL_26
PO_27:
    ds_read_b64_tr_b16 v[16:17], v136 offset:0
    ds_read_b64_tr_b16 v[18:19], v136 offset:4096
HOP_113:
    s_cbranch_execz HOP_114
    ds_read_b64_tr_b16 v[20:21], v136 offset:8192
    ds_read_b64_tr_b16 v[22:23], v136 offset:12288
    ds_read_b64_tr_b16 v[24:25], v136 offset:16384
    ds_read_b64_tr_b16 v[26:27], v136 offset:20480
    ds_read_b64_tr_b16 v[28:29], v136 offset:24576
    ds_read_b64_tr_b16 v[30:31], v136 offset:28672
    s_waitcnt lgkmcnt(6)
    v_mfma_f32_16x16x32_bf16 v[116:119], v[16:19], v[80:83], 0
HOP_114:
    s_cbranch_execz HOP_115
    s_waitcnt lgkmcnt(4)
    v_mfma_f32_16x16x32_bf16 v[116:119], v[20:23], v[84:87], v[116:119]
    s_waitcnt lgkmcnt(2)
    v_mfma_f32_16x16x32_bf16 v[116:119], v[24:27], v[88:91], v[116:119]
    s_waitcnt lgkmcnt(0)
    v_mfma_f32_16x16x32_bf16 v[116:119], v[28:31], v[92:95], v[116:119]
    s_mov_b32 s15, 524288
PL_28:
    ds_read_b32 v8, v2 offset:0
    s_sub_u32 s15, s15, 1
    s_cbranch_scc1 PO_29
HOP_115:
    s_cbranch_execz L_RESUME
    s_waitcnt lgkmcnt(0)
    v_readfirstlane_b32 s11, v8
    s_cmp_ge_u32 s11, 194
    s_cbranch_scc1 PO_29
    s_sleep 1
    s_branch PL_28
PO_29:
    ds_read_b64_tr_b16 v[32:33], v136 offset:32768
    ds_read_b64_tr_b16 v[34:35], v136 offset:36864
    ds_read_b64_tr_b16 v[36:37], v136 offset:40960
    ds_read_b64_tr_b16 v[38:39], v136 offset:45056
HOP_116:
HOPR_4:
    s_cbranch_execz HOP_117
    s_waitcnt lgkmcnt(2)
    v_mfma_f32_16x16x32_bf16 v[116:119], v[32:35], v[96:99], v[116:119]
    s_waitcnt lgkmcnt(0)
    v_mfma_f32_16x16x32_bf16 v[116:119], v[36:39], v[100:103], v[116:119]
    s_mov_b32 s15, 524288
PL_30:
    ds_read_b32 v8, v2 offset:0
    s_sub_u32 s15, s15, 1
    s_cbranch_scc1 PO_31
    s_waitcnt lgkmcnt(0)
    v_readfirstlane_b32 s11, v8
HOP_117:
    s_cbranch_execz HOP_118
    s_cmp_ge_u32 s11, 202
    s_cbranch_scc1 PO_31
    s_sleep 1
    s_branch PL_30
PO_31:
    ds_read_b64_tr_b16 v[40:41], v136 offset:49152
    ds_read_b64_tr_b16 v[42:43], v136 offset:53248
    s_waitcnt lgkmcnt(0)
    v_mfma_f32_16x16x32_bf16 v[116:119], v[40:43], v[104:107], v[116:119]
    s_mov_b32 s15, 524288
PL_32:
HOP_118:
    s_cbranch_execz HOP_119
    ds_read_b32 v8, v2 offset:0
    s_sub_u32 s15, s15, 1
    s_cbranch_scc1 PO_33
    s_waitcnt lgkmcnt(0)
    v_readfirstlane_b32 s11, v8
    s_cmp_ge_u32 s11, 210
    s_cbranch_scc1 PO_33
    s_sleep 1
    s_branch PL_32
PO_33:
    ds_read_b64_tr_b16 v[44:45], v136 offset:57344
    ds_read_b64_tr_b16 v[46:47], v136 offset:61440
HOP_119:
    s_cbranch_execz HOP_120
    s_waitcnt lgkmcnt(0)
    v_mfma_f32_16x16x32_bf16 v[116:119], v[44:47], v[108:111], v[116:119]
    s_mov_b64 exec, s[68:69]
    s_nop 6
    v_add_u32 v116, 0x80, v116
    v_add_u32 v117, 0x80, v117
    v_add_u32 v118, 0x80, v118
    v_add_u32 v119, 0x80, v119
    v_bfi_b32 v116, v3, s6, v116
HOP_120:
    s_cbranch_execz HOP_121
    v_bfi_b32 v117, v3, s7, v117
    v_bfi_b32 v118, v3, s8, v118
    v_bfi_b32 v119, v3, s9, v119
    buffer_store_dwordx4 v[116:119], v137, s[52:55], s26 offen
    ds_write_b128 v138, v[116:119] offset:10240
    s_mov_b64 exec, 1
    ds_add_u32 v2, v7 offset:12
    s_mov_b64 exec, -1
    s_cmp_ge_u32 s5, 27
HOP_121:
    s_cbranch_execz HOP_122
    s_cbranch_scc1 L_END
    s_cmp_lt_u32 s5, 18
    s_cbranch_scc1 L_COMPF
    s_mov_b32 s15, 524288
PL_34:
    ds_read_b32 v8, v2 offset:48
    s_sub_u32 s15, s15, 1
    s_cbranch_scc1 PO_35
    s_waitcnt lgkmcnt(0)
    v_readfirstlane_b32 s11, v8
    s_cmp_lt_u32 s11, 1
    s_cbranch_scc1 PL_34
PO_35:
    ds_read_b32 v161, v152 offset:128
HOP_122:
    s_cbranch_execz HOP_123
    ds_read_b32 v162, v152 offset:144
    ds_read_b32 v163, v152 offset:160
    ds_read_b32 v164, v152 offset:176
    s_mov_b32 s15, 524288
PL_36:
    ds_read_b32 v8, v2 offset:0
    s_sub_u32 s15, s15, 1
    s_cbranch_scc1 PO_37
    s_waitcnt lgkmcnt(0)
    v_readfirstlane_b32 s11, v8
    s_cmp_lt_u32 s11, s36
HOP_123:
    s_cbranch_execz HOP_124
    s_cbranch_scc1 PL_36
PO_37:
    ds_read_b64_tr_b16 v[16:17], v145 offset:0
    ds_read_b64_tr_b16 v[18:19], v145 offset:512
    ds_read_b64_tr_b16 v[20:21], v146 offset:0
    ds_read_b64_tr_b16 v[22:23], v146 offset:512
    ds_read_b64_tr_b16 v[24:25], v147 offset:0
    ds_read_b64_tr_b16 v[26:27], v147 offset:512
    ds_read_b64_tr_b16 v[28:29], v148 offset:0
HOP_124:
    s_cbranch_execz HOP_125
    ds_read_b64_tr_b16 v[30:31], v148 offset:512
    ds_read_b64_tr_b16 v[32:33], v145 offset:4096
    ds_read_b64_tr_b16 v[34:35], v145 offset:4608
    ds_read_b64_tr_b16 v[36:37], v146 offset:4096
    ds_read_b64_tr_b16 v[38:39], v146 offset:4608
    ds_read_b64_tr_b16 v[40:41], v147 offset:4096
    ds_read_b64_tr_b16 v[42:43], v147 offset:4608
HOP_125:
    s_cbranch_execz HOP_126
    ds_read_b64_tr_b16 v[44:45], v148 offset:4096
    ds_read_b64_tr_b16 v[46:47], v148 offset:4608
    s_mov_b32 s15, 32768
MG_38:
    buffer_load_dwordx4 v[80:83], v149, s[52:55], s70 offen sc1
    buffer_load_dwordx4 v[84:87], v149, s[52:55], s70 offen offset:1024 sc1
    buffer_load_dwordx4 v[88:91], v149, s[52:55], s70 offen offset:2048 sc1
    buffer_load_dwordx4 v[92:95], v149, s[52:55], s70 offen offset:3072 sc1
MC_39:
    s_waitcnt vmcnt(3)
HOP_126:
    s_cbranch_execz HOP_127
    v_xor_b32 v80, s6, v80
    v_xor_b32 v81, s7, v81
    v_xor_b32 v82, s8, v82
    v_xor_b32 v83, s9, v83
    v_or3_b32 v9, v80, v81, v82
    v_or_b32 v9, v9, v83
    v_mul_f32 v96, v80, v161
    v_mul_f32 v97, v81, v161
    v_mul_f32 v98, v82, v161
    v_mul_f32 v99, v83, v161
    s_waitcnt vmcnt(2)
    v_xor_b32 v84, s6, v84
    v_xor_b32 v85, s7, v85
    v_xor_b32 v86, s8, v86
HOP_127:
    s_cbranch_execz HOP_128
    v_xor_b32 v87, s9, v87
    v_or3_b32 v9, v9, v84, v85
    v_or3_b32 v9, v9, v86, v87
    v_fmac_f32 v96, v84, v162
    v_fmac_f32 v97, v85, v162
    v_fmac_f32 v98, v86, v162
    v_fmac_f32 v99, v87, v162
    s_waitcnt vmcnt(1)
    v_xor_b32 v88, s6, v88
    v_xor_b32 v89, s7, v89
    v_xor_b32 v90, s8, v90
    v_xor_b32 v91, s9, v91
HOP_128:
    s_cbranch_execz HOP_129
    v_or3_b32 v9, v9, v88, v89
    v_or3_b32 v9, v9, v90, v91
    v_mul_f32 v100, v88, v163
    v_mul_f32 v101, v89, v163
    v_mul_f32 v102, v90, v163
    v_mul_f32 v103, v91, v163
    s_waitcnt vmcnt(0)
    v_xor_b32 v92, s6, v92
    v_xor_b32 v93, s7, v93
    v_xor_b32 v94, s8, v94
    v_xor_b32 v95, s9, v95
    v_or3_b32 v9, v9, v92, v93
HOP_129:
    s_cbranch_execz HOP_130
    v_or3_b32 v9, v9, v94, v95
    v_fmac_f32 v100, v92, v164
    v_fmac_f32 v101, v93, v164
    v_fmac_f32 v102, v94, v164
    v_fmac_f32 v103, v95, v164
    v_and_b32 v9, v3, v9
    v_cmp_ne_u32 vcc, 0, v9
    s_cbranch_vccz MD_40
    s_sub_u32 s15, s15, 1
    s_cbranch_scc1 MD_40
    s_and_b32 s11, s15, 63
    s_cmp_eq_u32 s11, 0
    s_cselect_b32 s70, 0, 524288
HOP_130:
    s_cbranch_execz HOP_131
    s_add_u32 s70, s70, s71
    s_branch MG_38
MD_40:
    v_permlane32_swap_b32 v96, v100
    v_permlane32_swap_b32 v97, v101
    v_permlane32_swap_b32 v98, v102
    v_permlane32_swap_b32 v99, v103
    v_pk_add_f32 v[96:97], v[96:97], v[100:101]
    v_pk_add_f32 v[98:99], v[98:99], v[102:103]
    s_nop 1
    v_permlane16_swap_b32 v96, v98
    v_permlane16_swap_b32 v97, v99
    v_pk_add_f32 v[96:97], v[96:97], v[98:99]
HOP_131:
    s_cbranch_execz HOP_132
    v_cvt_pk_bf16_f32 v96, v96, v97
    ds_write_b32 v150, v96
    ds_read_b128 v[80:83], v141
    ds_read_b128 v[84:87], v142
    ds_read_b128 v[88:91], v143
    ds_read_b128 v[92:95], v144
    ds_read_b128 v[96:99], v141 offset:64
HOP_132:
    s_cbranch_execz HOP_133
    ds_read_b128 v[100:103], v142 offset:64
    ds_read_b128 v[104:107], v143 offset:64
    ds_read_b128 v[108:111], v144 offset:64
    s_waitcnt lgkmcnt(7)
    v_mfma_f32_16x16x32_bf16 v[116:119], v[16:19], v[80:83], 0
    s_waitcnt lgkmcnt(6)
    v_mfma_f32_16x16x32_bf16 v[116:119], v[20:23], v[84:87], v[116:119]
    s_waitcnt lgkmcnt(5)
    v_mfma_f32_16x16x32_bf16 v[116:119], v[24:27], v[88:91], v[116:119]
HOP_133:
    s_cbranch_execz HOP_134
    s_waitcnt lgkmcnt(4)
    v_mfma_f32_16x16x32_bf16 v[116:119], v[28:31], v[92:95], v[116:119]
    s_waitcnt lgkmcnt(3)
    v_mfma_f32_16x16x32_bf16 v[116:119], v[32:35], v[96:99], v[116:119]
    s_waitcnt lgkmcnt(2)
    v_mfma_f32_16x16x32_bf16 v[116:119], v[36:39], v[100:103], v[116:119]
    s_waitcnt lgkmcnt(1)
    v_mfma_f32_16x16x32_bf16 v[116:119], v[40:43], v[104:107], v[116:119]
    s_waitcnt lgkmcnt(0)
    v_mfma_f32_16x16x32_bf16 v[116:119], v[44:47], v[108:111], v[116:119]
HOP_134:
    s_cbranch_execz HOP_135
    s_mov_b32 exec_lo, 0x00ff00ff
    s_mov_b32 exec_hi, 0x00ff00ff
    s_nop 5
    ds_write_b128 v151, v[116:119]
    s_mov_b64 exec, -1
    s_waitcnt lgkmcnt(0)
    s_barrier
    s_cmp_lg_u32 s3, 0
    s_cbranch_scc1 L_NORELAY
    s_mov_b32 s40, s16
    s_and_b32 s41, s17, 0xffff
HOP_135:
    s_cbranch_execz HOP_136
    s_mov_b32 s42, 2304
    s_mov_b32 s43, 0x20000
    v_bfe_u32 v150, v0, 4, 1
    v_mul_u32_u24 v150, 1152, v150
    v_and_b32 v9, 15, v0
    v_lshl_add_u32 v150, v9, 3, v150
    v_lshrrev_b32 v9, 5, v0
    v_lshl_add_u32 v150, v9, 2, v150
    s_lshl_b32 s11, s74, 7
HOP_136:
    s_cbranch_execz HOP_137
    v_add_u32 v150, s11, v150
    buffer_load_dword v151, v150, s[40:43], 0 offen
    s_lshl_b32 s66, s74, 12
    s_add_u32 s66, s66, 1048576
    s_lshl_b32 s67, s4, 13
    s_lshl_b32 s11, s74, 9
    s_add_u32 s67, s67, s11
    s_add_u32 s67, s67, 405504
    s_waitcnt vmcnt(0)
    v_and_b32 v152, 0xffff0000, v151
    v_lshlrev_b32 v151, 16, v151
HOP_137:
    s_cbranch_execz HOP_138
    s_mov_b32 s15, 32768
MG_41:
    buffer_load_dwordx4 v[16:19], v149, s[52:55], s66 offen sc1
    buffer_load_dwordx4 v[20:23], v149, s[52:55], s66 offen offset:1024 sc1
    buffer_load_dwordx4 v[24:27], v149, s[52:55], s66 offen offset:2048 sc1
    buffer_load_dwordx4 v[28:31], v149, s[52:55], s66 offen offset:3072 sc1
MC_42:
    s_waitcnt vmcnt(3)
    v_xor_b32 v16, s6, v16
    v_xor_b32 v17, s7, v17
    v_xor_b32 v18, s8, v18
    v_xor_b32 v19, s9, v19
HOP_138:
    s_cbranch_execz HOP_139
    v_or3_b32 v9, v16, v17, v18
    v_or_b32 v9, v9, v19
    s_waitcnt vmcnt(2)
    v_xor_b32 v20, s6, v20
    v_xor_b32 v21, s7, v21
    v_xor_b32 v22, s8, v22
    v_xor_b32 v23, s9, v23
    v_or3_b32 v9, v9, v20, v21
    v_or3_b32 v9, v9, v22, v23
    v_pk_add_f32 v[68:69], v[16:17], v[20:21]
HOP_139:
    s_cbranch_execz HOP_140
    v_pk_add_f32 v[70:71], v[18:19], v[22:23]
    s_waitcnt vmcnt(1)
    v_xor_b32 v24, s6, v24
    v_xor_b32 v25, s7, v25
    v_xor_b32 v26, s8, v26
    v_xor_b32 v27, s9, v27
    v_or3_b32 v9, v9, v24, v25
    v_or3_b32 v9, v9, v26, v27
    v_pk_add_f32 v[68:69], v[68:69], v[24:25]
    v_pk_add_f32 v[70:71], v[70:71], v[26:27]
HOP_140:
    s_cbranch_execz HOP_141
    s_waitcnt vmcnt(0)
    v_xor_b32 v28, s6, v28
    v_xor_b32 v29, s7, v29
    v_xor_b32 v30, s8, v30
    v_xor_b32 v31, s9, v31
    v_or3_b32 v9, v9, v28, v29
    v_or3_b32 v9, v9, v30, v31
    v_pk_add_f32 v[68:69], v[68:69], v[28:29]
    v_pk_add_f32 v[70:71], v[70:71], v[30:31]
    v_and_b32 v9, v3, v9
    v_cmp_ne_u32 vcc, 0, v9
HOP_141:
    s_cbranch_execz HOP_142
    s_cbranch_vccz MD_43
    s_sub_u32 s15, s15, 1
    s_cbranch_scc1 MD_43
    s_branch MG_41
MD_43:
    v_permlane32_swap_b32 v68, v70
    v_permlane32_swap_b32 v69, v71
    v_pk_add_f32 v[68:69], v[68:69], v[70:71]
    v_cvt_pk_bf16_f32 v68, v68, v69
    v_and_b32 v69, 0xffff0000, v68
    v_lshlrev_b32 v68, 16, v68
    v_add_f32 v68, v68, v151
    v_add_f32 v69, v69, v152
HOP_142:
    s_cbranch_execz HOP_143
    v_cvt_pk_bf16_f32 v68, v68, v69
    v_mov_b32 v70, s76
    v_mov_b32 v69, v68
    v_mov_b32 v71, s76
    s_nop 0
    v_permlane32_swap_b32 v68, v69
    s_mov_b32 exec_hi, 0
    s_add_u32 s11, s67, 524288
    buffer_store_dwordx4 v[68:71], v149, s[52:55], s11 offen
    buffer_store_dwordx4 v[68:71], v149, s[52:55], s67 offen sc1
    s_mov_b64 exec, -1
L_NORELAY:
HOP_143:
    s_cbranch_execz HOP_144
    s_cmp_ge_u32 s63, 36
    s_cbranch_scc1 L_END
    s_mov_b32 s15, 524288
PL_44:
    ds_read_b32 v8, v2 offset:48
    s_sub_u32 s15, s15, 1
    s_cbranch_scc1 PO_45
    s_waitcnt lgkmcnt(0)
    v_readfirstlane_b32 s11, v8
    s_cmp_ge_u32 s11, 2
    s_cbranch_scc1 PO_45
    s_sleep 2
    s_branch PL_44
PO_45:
HOP_144:
    s_cbranch_execz L_RESUME
    s_mov_b32 s15, 32768
MG_46:
    buffer_load_dwordx4 v[80:83], v149, s[52:55], s37 offen sc1
    buffer_load_dwordx4 v[84:87], v149, s[52:55], s37 offen offset:1024 sc1
MC_47:
    s_waitcnt vmcnt(1)
    v_xor_b32 v80, s6, v80
    v_xor_b32 v81, s7, v81
    v_xor_b32 v82, s8, v82
    v_xor_b32 v83, s9, v83
    v_or3_b32 v9, v80, v81, v82
    v_or_b32 v9, v9, v83
    s_waitcnt vmcnt(0)
HOP_145:
HOPR_5:
    s_cbranch_execz HOP_146
    v_xor_b32 v84, s6, v84
    v_xor_b32 v85, s7, v85
    v_xor_b32 v86, s8, v86
    v_xor_b32 v87, s9, v87
    v_or3_b32 v9, v9, v84, v85
    v_or3_b32 v9, v9, v86, v87
    v_pk_add_f32 v[88:89], v[80:81], v[84:85]
    v_pk_add_f32 v[90:91], v[82:83], v[86:87]
    v_and_b32 v9, v3, v9
    v_cmp_ne_u32 vcc, 0, v9
    s_cbranch_vccz MD_48
HOP_146:
    s_cbranch_execz HOP_147
    s_sub_u32 s15, s15, 1
    s_cbranch_scc1 MD_48
    s_branch MG_46
MD_48:
    v_permlane32_swap_b32 v88, v90
    v_permlane32_swap_b32 v89, v91
    v_pk_add_f32 v[88:89], v[88:89], v[90:91]
    s_nop 1
    v_permlane16_swap_b32 v88, v89
    v_add_f32 v88, v88, v89
    s_nop 1
    v_add_f32_dpp v88, v88, v88 row_ror:8 row_mask:0xf bank_mask:0xf
    ds_write_b32 v160, v88 offset:8448
HOP_147:
    s_cbranch_execz HOP_148
    s_waitcnt lgkmcnt(0)
    s_barrier
    s_endpgm
L_COMPF:
    v_mov_b32 v80, 0x3f803f80
    v_mov_b32 v81, 0x3f803f80
    v_mov_b32 v82, 0x3f803f80
    v_mov_b32 v83, 0x3f803f80
    v_mov_b32 v84, 0x3f803f80
    v_mov_b32 v85, 0x3f803f80
HOP_148:
    s_cbranch_execz HOP_149
    v_mov_b32 v86, 0x3f803f80
    v_mov_b32 v87, 0x3f803f80
    v_mov_b32 v88, 0x3f803f80
    v_mov_b32 v89, 0x3f803f80
    v_mov_b32 v90, 0x3f803f80
    v_mov_b32 v91, 0x3f803f80
    v_mov_b32 v92, 0x3f803f80
HOP_149:
    s_cbranch_execz HOP_150
    v_mov_b32 v93, 0x3f803f80
    v_mov_b32 v94, 0x3f803f80
    v_mov_b32 v95, 0x3f803f80
    v_mov_b32 v96, 0x3f803f80
    v_mov_b32 v97, 0x3f803f80
    v_mov_b32 v98, 0x3f803f80
    v_mov_b32 v99, 0x3f803f80
HOP_150:
    s_cbranch_execz HOP_151
    v_mov_b32 v100, 0x3f803f80
    v_mov_b32 v101, 0x3f803f80
    v_mov_b32 v102, 0x3f803f80
    v_mov_b32 v103, 0x3f803f80
    v_mov_b32 v104, 0x3f803f80
    v_mov_b32 v105, 0x3f803f80
    v_mov_b32 v106, 0x3f803f80
HOP_151:
    s_cbranch_execz HOP_152
    v_mov_b32 v107, 0x3f803f80
    v_mov_b32 v108, 0x3f803f80
    v_mov_b32 v109, 0x3f803f80
    v_mov_b32 v110, 0x3f803f80
    v_mov_b32 v111, 0x3f803f80
    v_mov_b32 v112, 0x3f803f80
    v_mov_b32 v113, 0x3f803f80
HOP_152:
    s_cbranch_execz HOP_153
    v_mov_b32 v114, 0x3f803f80
    v_mov_b32 v115, 0x3f803f80
    s_xor_b32 s12, s3, s5
    s_and_b32 s12, s12, 1
    s_mul_i32 s12, s12, 36
    s_add_u32 s64, s12, 230
    s_cmp_ge_u32 s3, 4
    s_cselect_b32 s12, 24, 8
    s_cselect_b32 s13, 32, 12
    s_cselect_b32 s11, 36, 20
    s_add_u32 s65, s64, s12
    s_add_u32 s66, s64, s13
HOP_153:
    s_cbranch_execz HOP_154
    s_add_u32 s67, s64, s11
    s_mov_b32 s75, 0
    s_mov_b32 s15, 524288
L_FW:
    ds_read_b64 v[8:9], v2 offset:0
    s_sub_u32 s15, s15, 1
    s_cbranch_scc1 L_FW2
    s_waitcnt lgkmcnt(0)
    v_readfirstlane_b32 s12, v9
    v_readfirstlane_b32 s11, v8
    s_cmp_ge_u32 s12, 10
    s_cbranch_scc1 L_FW2
    s_cmp_lt_u32 s11, s67
    s_cbranch_scc1 L_FW
HOP_154:
    s_cbranch_execz HOP_155
    ds_read_b64_tr_b16 v[32:33], v153 offset:0
    ds_read_b64_tr_b16 v[34:35], v153 offset:256
    ds_read_b64_tr_b16 v[36:37], v153 offset:2048
    ds_read_b64_tr_b16 v[38:39], v153 offset:2304
    ds_read_b64_tr_b16 v[40:41], v153 offset:4096
    ds_read_b64_tr_b16 v[42:43], v153 offset:4352
    ds_read_b64_tr_b16 v[44:45], v153 offset:6144
HOP_155:
    s_cbranch_execz HOP_156
    ds_read_b64_tr_b16 v[46:47], v153 offset:6400
    ds_read_b64_tr_b16 v[48:49], v153 offset:8192
    ds_read_b64_tr_b16 v[50:51], v153 offset:8448
    ds_read_b64_tr_b16 v[52:53], v153 offset:10240
    ds_read_b64_tr_b16 v[54:55], v153 offset:10496
    ds_read_b64_tr_b16 v[56:57], v153 offset:12288
    ds_read_b64_tr_b16 v[58:59], v153 offset:12544
HOP_156:
    s_cbranch_execz HOP_157
    ds_read_b64_tr_b16 v[60:61], v153 offset:14336
    ds_read_b64_tr_b16 v[62:63], v153 offset:14592
    ds_read_b64_tr_b16 v[64:65], v153 offset:16384
    ds_read_b64_tr_b16 v[66:67], v153 offset:16640
    s_mov_b32 s75, 1
L_FW3:
    ds_read_b64 v[8:9], v2 offset:0
    s_sub_u32 s15, s15, 1
    s_cbranch_scc1 L_FW2
    s_waitcnt lgkmcnt(0)
    v_readfirstlane_b32 s12, v9
HOP_157:
    s_cbranch_execz HOP_158
    v_readfirstlane_b32 s11, v8
    s_cmp_ge_u32 s12, 10
    s_cbranch_scc1 L_FW2
    s_cmp_lt_u32 s11, 338
    s_cbranch_scc1 L_FW3
    ds_read_b64_tr_b16 v[16:17], v145 offset:0
    ds_read_b64_tr_b16 v[18:19], v145 offset:512
    ds_read_b64_tr_b16 v[20:21], v146 offset:0
    ds_read_b64_tr_b16 v[22:23], v146 offset:512
HOP_158:
    s_cbranch_execz HOP_159
    ds_read_b64_tr_b16 v[24:25], v147 offset:0
    ds_read_b64_tr_b16 v[26:27], v147 offset:512
    ds_read_b64_tr_b16 v[28:29], v148 offset:0
    ds_read_b64_tr_b16 v[30:31], v148 offset:512
    s_mov_b32 s75, 3
    s_mov_b32 s15, 524288
PL_49:
    ds_read_b32 v8, v2 offset:4
    s_sub_u32 s15, s15, 1
    s_cbranch_scc1 PO_50
HOP_159:
    s_cbranch_execz HOP_160
    s_waitcnt lgkmcnt(0)
    v_readfirstlane_b32 s11, v8
    s_cmp_lt_u32 s11, 10
    s_cbranch_scc1 PL_49
PO_50:
L_FW2:
    s_mov_b64 exec, s[68:69]
    ds_read_b128 v[80:83], v154 offset:0
    ds_read_b128 v[84:87], v154 offset:64
    ds_read_b128 v[88:91], v154 offset:128
    ds_read_b128 v[92:95], v154 offset:192
    ds_read_b128 v[96:99], v154 offset:256
HOP_160:
    s_cbranch_execz HOP_161
    ds_read_b128 v[100:103], v154 offset:320
    ds_read_b128 v[104:107], v154 offset:384
    ds_read_b128 v[108:111], v154 offset:448
    ds_read_b128 v[112:115], v154 offset:512
    s_mov_b64 exec, -1
    s_cmp_eq_u32 s75, 0
    s_cbranch_scc1 L_FST
    s_waitcnt lgkmcnt(8)
    v_mfma_f32_16x16x32_bf16 v[116:119], v[32:35], v[80:83], 0
    s_waitcnt lgkmcnt(7)
HOP_161:
    s_cbranch_execz HOP_162
    v_mfma_f32_16x16x32_bf16 v[116:119], v[36:39], v[84:87], v[116:119]
    s_waitcnt lgkmcnt(6)
    v_mfma_f32_16x16x32_bf16 v[116:119], v[40:43], v[88:91], v[116:119]
    s_waitcnt lgkmcnt(5)
    v_mfma_f32_16x16x32_bf16 v[116:119], v[44:47], v[92:95], v[116:119]
    s_waitcnt lgkmcnt(4)
    v_mfma_f32_16x16x32_bf16 v[116:119], v[48:51], v[96:99], v[116:119]
    s_waitcnt lgkmcnt(3)
    v_mfma_f32_16x16x32_bf16 v[116:119], v[52:55], v[100:103], v[116:119]
    s_waitcnt lgkmcnt(2)
HOP_162:
    s_cbranch_execz HOP_163
    v_mfma_f32_16x16x32_bf16 v[116:119], v[56:59], v[104:107], v[116:119]
    s_waitcnt lgkmcnt(1)
    v_mfma_f32_16x16x32_bf16 v[116:119], v[60:63], v[108:111], v[116:119]
    s_waitcnt lgkmcnt(0)
    v_mfma_f32_16x16x32_bf16 v[116:119], v[64:67], v[112:115], v[116:119]
    s_branch L_F1E
L_FST:
    s_mov_b32 s15, 524288
PL_51:
    ds_read_b32 v8, v2 offset:0
    s_sub_u32 s15, s15, 1
    s_cbranch_scc1 PO_52
HOP_163:
    s_cbranch_execz HOP_164
    s_waitcnt lgkmcnt(0)
    v_readfirstlane_b32 s11, v8
    s_cmp_lt_u32 s11, s65
    s_cbranch_scc1 PL_51
PO_52:
    ds_read_b64_tr_b16 v[32:33], v153 offset:0
    ds_read_b64_tr_b16 v[34:35], v153 offset:256
    ds_read_b64_tr_b16 v[36:37], v153 offset:2048
    ds_read_b64_tr_b16 v[38:39], v153 offset:2304
    ds_read_b64_tr_b16 v[40:41], v153 offset:4096
HOP_164:
    s_cbranch_execz HOP_165
    ds_read_b64_tr_b16 v[42:43], v153 offset:4352
    s_waitcnt lgkmcnt(4)
    v_mfma_f32_16x16x32_bf16 v[116:119], v[32:35], v[80:83], 0
    s_waitcnt lgkmcnt(2)
    v_mfma_f32_16x16x32_bf16 v[116:119], v[36:39], v[84:87], v[116:119]
    s_waitcnt lgkmcnt(0)
    v_mfma_f32_16x16x32_bf16 v[116:119], v[40:43], v[88:91], v[116:119]
    s_mov_b32 s15, 524288
PL_53:
    ds_read_b32 v8, v2 offset:0
HOP_165:
    s_cbranch_execz HOP_166
    s_sub_u32 s15, s15, 1
    s_cbranch_scc1 PO_54
    s_waitcnt lgkmcnt(0)
    v_readfirstlane_b32 s11, v8
    s_cmp_lt_u32 s11, s66
    s_cbranch_scc1 PL_53
PO_54:
    ds_read_b64_tr_b16 v[44:45], v153 offset:6144
    ds_read_b64_tr_b16 v[46:47], v153 offset:6400
    ds_read_b64_tr_b16 v[48:49], v153 offset:8192
    ds_read_b64_tr_b16 v[50:51], v153 offset:8448
HOP_166:
    s_cbranch_execz HOP_167
    ds_read_b64_tr_b16 v[52:53], v153 offset:10240
    ds_read_b64_tr_b16 v[54:55], v153 offset:10496
    s_waitcnt lgkmcnt(4)
    v_mfma_f32_16x16x32_bf16 v[116:119], v[44:47], v[92:95], v[116:119]
    s_waitcnt lgkmcnt(2)
    v_mfma_f32_16x16x32_bf16 v[116:119], v[48:51], v[96:99], v[116:119]
    s_waitcnt lgkmcnt(0)
    v_mfma_f32_16x16x32_bf16 v[116:119], v[52:55], v[100:103], v[116:119]
    s_mov_b32 s15, 524288
PL_55:
HOP_167:
    s_cbranch_execz HOP_168
    ds_read_b32 v8, v2 offset:0
    s_sub_u32 s15, s15, 1
    s_cbranch_scc1 PO_56
    s_waitcnt lgkmcnt(0)
    v_readfirstlane_b32 s11, v8
    s_cmp_lt_u32 s11, s67
    s_cbranch_scc1 PL_55
PO_56:
    ds_read_b64_tr_b16 v[56:57], v153 offset:12288
    ds_read_b64_tr_b16 v[58:59], v153 offset:12544
    ds_read_b64_tr_b16 v[60:61], v153 offset:14336
HOP_168:
    s_cbranch_execz HOP_169
    ds_read_b64_tr_b16 v[62:63], v153 offset:14592
    ds_read_b64_tr_b16 v[64:65], v153 offset:16384
    ds_read_b64_tr_b16 v[66:67], v153 offset:16640
    s_waitcnt lgkmcnt(4)
    v_mfma_f32_16x16x32_bf16 v[116:119], v[56:59], v[104:107], v[116:119]
    s_waitcnt lgkmcnt(2)
    v_mfma_f32_16x16x32_bf16 v[116:119], v[60:63], v[108:111], v[116:119]
    s_waitcnt lgkmcnt(0)
    v_mfma_f32_16x16x32_bf16 v[116:119], v[64:67], v[112:115], v[116:119]
L_F1E:
HOP_169:
    s_cbranch_execz HOP_170
    s_mov_b32 exec_lo, 0x00070007
    s_mov_b32 exec_hi, 0x00070007
    s_nop 5
    ds_write_b128 v155, v[116:119] offset:5760
    s_mov_b64 exec, -1
    s_cmp_eq_u32 s75, 3
    s_waitcnt lgkmcnt(0)
    s_cbranch_scc1 L_F2B
    s_mov_b32 s15, 524288
PL_57:
    ds_read_b32 v8, v2 offset:0
HOP_170:
    s_cbranch_execz HOP_171
    s_sub_u32 s15, s15, 1
    s_cbranch_scc1 PO_58
    s_waitcnt lgkmcnt(0)
    v_readfirstlane_b32 s11, v8
    s_cmp_lt_u32 s11, 338
    s_cbranch_scc1 PL_57
PO_58:
L_F2:
    ds_read_b64_tr_b16 v[16:17], v145 offset:0
    ds_read_b64_tr_b16 v[18:19], v145 offset:512
    ds_read_b64_tr_b16 v[20:21], v146 offset:0
    ds_read_b64_tr_b16 v[22:23], v146 offset:512
HOP_171:
    s_cbranch_execz HOP_172
    ds_read_b64_tr_b16 v[24:25], v147 offset:0
    ds_read_b64_tr_b16 v[26:27], v147 offset:512
    ds_read_b64_tr_b16 v[28:29], v148 offset:0
    ds_read_b64_tr_b16 v[30:31], v148 offset:512
L_F2B:
    s_barrier
    ds_read_b32 v120, v157 offset:5760
    ds_read_b32 v122, v157 offset:6144
    ds_read_b32 v121, v157 offset:6528
HOP_172:
    s_cbranch_execz HOP_173
    ds_read_b32 v123, v157 offset:6912
    ds_read_b32 v124, v158 offset:6016
    ds_read_b32 v126, v158 offset:6400
    ds_read_b32 v125, v158 offset:6784
    ds_read_b32 v127, v158 offset:7168
    ds_read_b64 v[128:129], v159 offset:64
    s_waitcnt lgkmcnt(5)
    v_pk_add_f32 v[120:121], v[120:121], v[122:123]
HOP_173:
    s_cbranch_execz L_RESUME
    s_waitcnt lgkmcnt(1)
    v_pk_add_f32 v[124:125], v[124:125], v[126:127]
    s_waitcnt lgkmcnt(0)
    v_fmac_f32 v120, v124, v128
    v_fmac_f32 v121, v125, v128
    v_mul_f32 v120, v120, v129
    v_mul_f32 v121, v121, v129
    v_cvt_pk_bf16_f32 v120, v120, v121
    v_lshlrev_b32 v122, 16, v120
    v_and_b32 v124, 0xffff0000, v120
    v_mul_f32 v121, 0xbfb8aa3b, v122
HOP_174:
HOPR_6:
    s_cbranch_execz HOP_175
    v_exp_f32 v121, v121
    s_nop 0
    v_add_f32 v121, 1.0, v121
    v_rcp_f32 v121, v121
    s_nop 0
    v_mul_f32 v121, v122, v121
    v_cvt_pk_bf16_f32 v121, v121, v121
    v_lshlrev_b32 v121, 16, v121
    v_mul_f32 v121, v121, v124
    v_cvt_pk_bf16_f32 v121, v121, v121
    ds_write_b16 v156, v121
HOP_175:
    s_cbranch_execz HOP_176
    ds_read_b128 v[80:83], v141
    ds_read_b128 v[84:87], v142
    ds_read_b128 v[88:91], v143
    ds_read_b128 v[92:95], v144
    s_waitcnt lgkmcnt(3)
    v_mfma_f32_16x16x32_bf16 v[116:119], v[16:19], v[80:83], 0
    s_waitcnt lgkmcnt(2)
    v_mfma_f32_16x16x32_bf16 v[116:119], v[20:23], v[84:87], v[116:119]
    s_waitcnt lgkmcnt(1)
HOP_176:
    s_cbranch_execz HOP_177
    v_mfma_f32_16x16x32_bf16 v[116:119], v[24:27], v[88:91], v[116:119]
    s_waitcnt lgkmcnt(0)
    v_mfma_f32_16x16x32_bf16 v[116:119], v[28:31], v[92:95], v[116:119]
    s_mov_b32 exec_lo, 0x00ff00ff
    s_mov_b32 exec_hi, 0x00ff00ff
    s_nop 5
    v_add_u32 v116, 0x80, v116
    v_add_u32 v117, 0x80, v117
HOP_177:
    s_cbranch_execz HOP_178
    v_add_u32 v118, 0x80, v118
    v_add_u32 v119, 0x80, v119
    v_bfi_b32 v116, v3, s6, v116
    v_bfi_b32 v117, v3, s7, v117
    v_bfi_b32 v118, v3, s8, v118
    v_bfi_b32 v119, v3, s9, v119
    buffer_store_dwordx4 v[116:119], v140, s[52:55], s36 offen sc1
    s_mov_b64 exec, -1
HOP_178:
    s_cbranch_execz HOP_179
    s_endpgm
L_COMM2:
    v_lshlrev_b32 v128, 16, v128
    s_lshl_b32 s64, s61, 4
    s_add_u32 s64, s64, s60
    s_lshl_b32 s64, s64, 12
    s_add_u32 s64, s64, 4096
    s_add_u32 s65, s64, 524288
    v_lshlrev_b32 v138, 3, v0
    s_mov_b32 s15, 524288
PL_59:
    ds_read_b32 v8, v2 offset:0
    s_sub_u32 s15, s15, 1
HOP_179:
    s_cbranch_execz HOP_180
    s_cbranch_scc1 PO_60
    s_waitcnt lgkmcnt(0)
    v_readfirstlane_b32 s11, v8
    s_cmp_ge_u32 s11, 118
    s_cbranch_scc1 PO_60
    s_sleep 2
    s_branch PL_59
PO_60:
    s_mov_b32 s15, 32768
L_QG:
    buffer_load_dwordx4 v[16:19], v149, s[52:55], s65 offen offset:0 sc1
    buffer_load_dwordx4 v[20:23], v149, s[52:55], s65 offen offset:1024 sc1
HOP_180:
    s_cbranch_execz HOP_181
    buffer_load_dwordx4 v[24:27], v149, s[52:55], s65 offen offset:2048 sc1
    buffer_load_dwordx4 v[28:31], v149, s[52:55], s65 offen offset:3072 sc1
    s_waitcnt vmcnt(3)
    v_xor_b32 v16, s6, v16
    v_xor_b32 v17, s7, v17
    v_xor_b32 v18, s8, v18
    v_xor_b32 v19, s9, v19
    v_or3_b32 v9, v16, v17, v18
    v_or_b32 v9, v9, v19
    s_waitcnt vmcnt(2)
    v_xor_b32 v20, s6, v20
    v_xor_b32 v21, s7, v21
HOP_181:
    s_cbranch_execz HOP_182
    v_xor_b32 v22, s8, v22
    v_xor_b32 v23, s9, v23
    v_or3_b32 v9, v9, v20, v21
    v_or3_b32 v9, v9, v22, v23
    s_waitcnt vmcnt(1)
    v_xor_b32 v24, s6, v24
    v_xor_b32 v25, s7, v25
    v_xor_b32 v26, s8, v26
    v_xor_b32 v27, s9, v27
    v_or3_b32 v9, v9, v24, v25
    v_or3_b32 v9, v9, v26, v27
HOP_182:
    s_cbranch_execz HOP_183
    s_waitcnt vmcnt(0)
    v_xor_b32 v28, s6, v28
    v_xor_b32 v29, s7, v29
    v_xor_b32 v30, s8, v30
    v_xor_b32 v31, s9, v31
    v_or3_b32 v9, v9, v28, v29
    v_or3_b32 v9, v9, v30, v31
    v_and_b32 v9, v3, v9
    v_cmp_ne_u32 vcc, 0, v9
    s_cbranch_vccz L_QGD
    s_sub_u32 s15, s15, 1
    s_cbranch_scc1 L_QGD
    s_and_b32 s11, s15, 3
HOP_183:
    s_cbranch_execz HOP_184
    s_cmp_eq_u32 s11, 0
    s_cselect_b32 s65, 0, 524288
    s_add_u32 s65, s65, s64
    s_branch L_QG
L_QGD:
    v_pk_add_f32 v[80:81], v[16:17], v[20:21]
    v_pk_add_f32 v[84:85], v[24:25], v[28:29]
    v_pk_add_f32 v[80:81], v[80:81], v[84:85]
    v_pk_add_f32 v[82:83], v[18:19], v[22:23]
    v_pk_add_f32 v[86:87], v[26:27], v[30:31]
HOP_184:
    s_cbranch_execz HOP_185
    v_pk_add_f32 v[82:83], v[82:83], v[86:87]
    v_cvt_pk_bf16_f32 v80, v80, v81
    v_cvt_pk_bf16_f32 v81, v82, v83
    ds_write_b64 v138, v[80:81] offset:4096
    ds_write_b32 v2, v7 offset:8
    v_lshlrev_b32 v137, 5, v5
    v_lshlrev_b32 v138, 8, v5
    s_lshl_b32 s64, s60, 9
    s_and_b32 s12, s5, 15
    s_lshl_b32 s12, s12, 4
HOP_185:
    s_cbranch_execz HOP_186
    s_add_u32 s64, s64, s12
    s_add_u32 s64, s64, 135168
    v_lshrrev_b32 v139, 5, v0
    v_lshlrev_b32 v139, 13, v139
    v_bfe_u32 v136, v0, 4, 1
    v_lshl_add_u32 v139, v136, 12, v139
    v_and_b32 v136, 15, v0
    v_lshl_add_u32 v139, v136, 4, v139
    s_lshl_b32 s26, s60, 14
    s_and_b32 s12, s5, 15
    s_lshl_b32 s12, s12, 8
HOP_186:
    s_cbranch_execz HOP_187
    s_add_u32 s26, s26, s12
    s_add_u32 s26, s26, 143360
    s_mov_b32 s15, 524288
PL_61:
    ds_read_b32 v8, v2 offset:40
    s_sub_u32 s15, s15, 1
    s_cbranch_scc1 PO_62
    s_waitcnt lgkmcnt(0)
    v_readfirstlane_b32 s11, v8
    s_cmp_ge_u32 s11, 8
    s_cbranch_scc1 PO_62
    s_sleep 1
    s_branch PL_61
PO_62:
HOP_187:
    s_cbranch_execz HOP_188
    ds_read_b128 v[16:19], v137 offset:9984
    ds_read_b128 v[20:23], v137 offset:10000
    ds_read_b128 v[24:27], v137 offset:10048
    ds_read_b128 v[28:31], v137 offset:10064
    s_waitcnt lgkmcnt(0)
    v_max3_f32 v80, v16, v17, v18
    v_max3_f32 v80, v80, v19, v20
    v_max3_f32 v80, v80, v21, v22
HOP_188:
    s_cbranch_execz HOP_189
    v_max_f32 v80, v80, v23
    v_pk_add_f32 v[24:25], v[24:25], v[26:27]
    v_pk_add_f32 v[28:29], v[28:29], v[30:31]
    v_pk_add_f32 v[24:25], v[24:25], v[28:29]
    v_add_f32 v81, v24, v25
    v_mov_b32 v82, v80
    v_mov_b32 v83, v81
    v_add_u32 v80, 0x80, v80
    v_add_u32 v81, 0x80, v81
HOP_189:
    s_cbranch_execz HOP_190
    v_add_u32 v82, 0x80, v82
    v_add_u32 v83, 0x80, v83
    v_bfi_b32 v80, v3, s6, v80
    v_bfi_b32 v81, v3, s7, v81
    v_bfi_b32 v82, v3, s8, v82
    v_bfi_b32 v83, v3, s9, v83
    s_mov_b64 exec, 3
    s_add_u32 s11, s64, 524288
HOP_190:
    s_cbranch_execz HOP_191
    buffer_store_dwordx4 v[80:83], v138, s[52:55], s11 offen
    buffer_store_dwordx4 v[80:83], v138, s[52:55], s64 offen sc1
    s_mov_b64 exec, -1
    s_sub_u32 s12, s5, 18
    s_cmp_lt_u32 s12, 9
    s_cbranch_scc1 L_COMMW
    s_mov_b32 s15, 524288
PL_63:
    ds_read_b32 v8, v2 offset:12
    s_sub_u32 s15, s15, 1
    s_cbranch_scc1 PO_64
    s_waitcnt lgkmcnt(0)
HOP_191:
    s_cbranch_execz HOP_192
    v_readfirstlane_b32 s11, v8
    s_cmp_ge_u32 s11, 16
    s_cbranch_scc1 PO_64
    s_sleep 2
    s_branch PL_63
PO_64:
    ds_read_b128 v[84:87], v149 offset:10240
    s_waitcnt lgkmcnt(0)
    buffer_store_dwordx4 v[84:87], v139, s[52:55], s26 offen sc1
    s_cmp_ge_u32 s5, 27
    s_cbranch_scc1 L_END
    s_mov_b32 s66, 0x3f803f80
HOP_192:
    s_cbranch_execz HOP_193
    v_bfe_u32 v159, v0, 4, 1
    v_mul_u32_u24 v134, 1152, v159
    v_lshlrev_b32 v159, 3, v159
    v_lshrrev_b32 v135, 5, v0
    v_lshl_add_u32 v134, v135, 7, v134
    v_and_b32 v135, 15, v0
    v_lshl_add_u32 v134, v135, 3, v134
    v_mov_b32 v138, 16
    s_lshl_b32 s65, s4, 13
    s_add_u32 s65, s65, 405504
HOP_193:
    s_cbranch_execz HOP_194
    s_add_u32 s64, s65, 524288
    v_mov_b32 v32, 0
    v_mov_b32 v33, 0
    v_mov_b32 v34, s76
    v_mov_b32 v35, s76
    v_add_u32 v135, 4096, v149
    s_mov_b32 s15, 524288
PL_65:
    ds_read_b32 v8, v2 offset:0
    s_sub_u32 s15, s15, 1
    s_cbranch_scc1 PO_66
    s_waitcnt lgkmcnt(0)
HOP_194:
    s_cbranch_execz HOP_195
    v_readfirstlane_b32 s11, v8
    s_cmp_ge_u32 s11, 266
    s_cbranch_scc1 PO_66
    s_sleep 4
    s_branch PL_65
PO_66:
    s_mov_b32 s15, 32768
L_HG:
    buffer_load_dwordx4 v[16:19], v149, s[52:55], s64 offen offset:0 sc1
    buffer_load_dwordx4 v[20:23], v149, s[52:55], s64 offen offset:1024 sc1
    buffer_load_dwordx4 v[24:27], v149, s[52:55], s64 offen offset:2048 sc1
HOP_195:
    s_cbranch_execz HOP_196
    buffer_load_dwordx4 v[28:31], v149, s[52:55], s64 offen offset:3072 sc1
    s_mov_b32 exec_hi, 0
    buffer_load_dwordx4 v[32:35], v135, s[52:55], s64 offen sc1
    s_mov_b64 exec, -1
    s_waitcnt vmcnt(4)
    ds_write_b64 v134, v[16:17] offset:512
    v_xor_b32 v11, s76, v18
    v_bitop3_b32 v11, v11, v19, s76 bitop3:0xf6
    s_waitcnt vmcnt(3)
    ds_write_b64 v134, v[20:21] offset:768
HOP_196:
    s_cbranch_execz HOP_197
    v_bitop3_b32 v11, v11, v22, s76 bitop3:0xf6
    v_bitop3_b32 v11, v11, v23, s76 bitop3:0xf6
    s_waitcnt vmcnt(2)
    ds_write_b64 v134, v[24:25] offset:1024
    v_bitop3_b32 v11, v11, v26, s76 bitop3:0xf6
    v_bitop3_b32 v11, v11, v27, s76 bitop3:0xf6
    s_waitcnt vmcnt(1)
    ds_write_b64 v134, v[28:29] offset:1280
HOP_197:
    s_cbranch_execz HOP_198
    v_bitop3_b32 v11, v11, v30, s76 bitop3:0xf6
    v_bitop3_b32 v11, v11, v31, s76 bitop3:0xf6
    s_waitcnt vmcnt(0)
    s_mov_b32 exec_hi, 0
    ds_write_b64 v134, v[32:33] offset:1536
    s_mov_b64 exec, -1
    v_bitop3_b32 v11, v11, v34, s76 bitop3:0xf6
    v_bitop3_b32 v11, v11, v35, s76 bitop3:0xf6
    v_cmp_ne_u32 vcc, 0, v11
    s_cbranch_vccz L_HOK0
HOP_198:
    s_cbranch_execz HOP_199
    s_sub_u32 s15, s15, 1
    s_cbranch_scc1 L_HTO
    s_and_b32 s11, s15, 63
    s_cmp_eq_u32 s11, 0
    s_cselect_b32 s64, 0, 524288
    s_add_u32 s64, s64, s65
    s_branch L_HG
L_HTO:
    s_waitcnt vmcnt(0)
L_HOK0:
    ds_write_b32 v2, v138 offset:4
    v_dot2_f32_bf16 v8, v16, s66, 0
    v_dot2_f32_bf16 v9, v16, v16, 0
HOP_199:
    s_cbranch_execz HOP_200
    v_dot2_f32_bf16 v8, v17, s66, v8
    v_dot2_f32_bf16 v9, v17, v17, v9
    v_dot2_f32_bf16 v8, v20, s66, v8
    v_dot2_f32_bf16 v9, v20, v20, v9
    v_dot2_f32_bf16 v8, v21, s66, v8
    v_dot2_f32_bf16 v9, v21, v21, v9
    v_dot2_f32_bf16 v8, v24, s66, v8
HOP_200:
    s_cbranch_execz HOP_201
    v_dot2_f32_bf16 v9, v24, v24, v9
    v_dot2_f32_bf16 v8, v25, s66, v8
    v_dot2_f32_bf16 v9, v25, v25, v9
    v_dot2_f32_bf16 v8, v28, s66, v8
    v_dot2_f32_bf16 v9, v28, v28, v9
    v_dot2_f32_bf16 v8, v29, s66, v8
    v_dot2_f32_bf16 v9, v29, v29, v9
HOP_201:
    s_cbranch_execz HOP_202
    v_dot2_f32_bf16 v8, v32, s66, v8
    v_dot2_f32_bf16 v9, v32, v32, v9
    v_dot2_f32_bf16 v8, v33, s66, v8
    v_dot2_f32_bf16 v9, v33, v33, v9
L_HST:
    s_nop 2
    v_add_f32_dpp v8, v8, v8 quad_perm:[1,0,3,2] row_mask:0xf bank_mask:0xf
    v_add_f32_dpp v9, v9, v9 quad_perm:[1,0,3,2] row_mask:0xf bank_mask:0xf
    s_nop 0
HOP_202:
    s_cbranch_execz L_RESUME
    v_add_f32_dpp v8, v8, v8 quad_perm:[2,3,0,1] row_mask:0xf bank_mask:0xf
    v_add_f32_dpp v9, v9, v9 quad_perm:[2,3,0,1] row_mask:0xf bank_mask:0xf
    s_nop 0
    v_add_f32_dpp v8, v8, v8 row_half_mirror row_mask:0xf bank_mask:0xf
    v_add_f32_dpp v9, v9, v9 row_half_mirror row_mask:0xf bank_mask:0xf
    s_nop 0
    v_add_f32_dpp v8, v8, v8 row_mirror row_mask:0xf bank_mask:0xf
    v_add_f32_dpp v9, v9, v9 row_mirror row_mask:0xf bank_mask:0xf
    v_mov_b32 v10, v8
HOP_203:
HOPR_7:
    s_cbranch_execz HOP_204
    v_mov_b32 v11, v9
    s_nop 0
    v_permlane32_swap_b32 v8, v10
    v_permlane32_swap_b32 v9, v11
    v_add_f32 v8, v8, v10
    v_add_f32 v9, v9, v11
    v_mul_f32 v8, 0x3ae38e39, v8
    v_mul_f32 v9, 0x3ae38e39, v9
    v_fma_f32 v9, -v8, v8, v9
    v_max_f32 v9, 0, v9
    v_cvt_pk_bf16_f32 v10, v8, v9
HOP_204:
    s_cbranch_execz HOP_205
    v_and_b32 v9, 0xffff0000, v10
    v_lshlrev_b32 v8, 16, v10
    v_add_f32 v9, 0x3727c5ac, v9
    v_xor_b32 v8, 0x80000000, v8
    v_cvt_pk_bf16_f32 v9, v9, v9
    v_lshlrev_b32 v9, 16, v9
    v_sqrt_f32 v9, v9
    s_nop 0
    v_cvt_pk_bf16_f32 v9, v9, v9
    v_lshlrev_b32 v9, 16, v9
HOP_205:
    s_cbranch_execz HOP_206
    v_rcp_f32 v9, v9
    s_nop 0
    ds_write_b64 v159, v[8:9] offset:64
    s_waitcnt lgkmcnt(0)
    s_barrier
    s_endpgm
L_COMMW:
    s_lshl_b32 s65, s4, 10
    s_add_u32 s65, s65, 135168
    s_add_u32 s64, s65, 524288
    s_mov_b32 s13, 0x3fb8aa3b
    v_lshlrev_b32 v132, 2, v0
HOP_206:
    s_cbranch_execz HOP_207
    s_mov_b32 s15, 524288
PL_67:
    ds_read_b32 v8, v2 offset:0
    s_sub_u32 s15, s15, 1
    s_cbranch_scc1 PO_68
    s_waitcnt lgkmcnt(0)
    v_readfirstlane_b32 s11, v8
    s_cmp_ge_u32 s11, 194
    s_cbranch_scc1 PO_68
    s_sleep 2
    s_branch PL_67
PO_68:
    s_mov_b32 s15, 32768
L_SG:
HOP_207:
    s_cbranch_execz HOP_208
    buffer_load_dwordx4 v[88:91], v149, s[52:55], s64 offen sc1
    s_waitcnt vmcnt(0)
    v_xor_b32 v88, s6, v88
    v_xor_b32 v89, s7, v89
    v_xor_b32 v90, s8, v90
    v_xor_b32 v91, s9, v91
    v_or3_b32 v9, v88, v89, v90
    v_or_b32 v9, v9, v91
    v_and_b32 v9, v3, v9
    v_cmp_ne_u32 vcc, 0, v9
    s_cbranch_vccz L_SGD
    s_sub_u32 s15, s15, 1
    s_cbranch_scc1 L_SGD
HOP_208:
    s_cbranch_execz HOP_209
    s_and_b32 s11, s15, 15
    s_cmp_eq_u32 s11, 0
    s_cselect_b32 s64, 0, 524288
    s_add_u32 s64, s64, s65
    s_branch L_SG
L_SGD:
    v_max_f32_dpp v92, v88, v88 quad_perm:[1,0,3,2] row_mask:0xf bank_mask:0xf
    s_nop 1
    v_max_f32_dpp v92, v92, v92 quad_perm:[2,3,0,1] row_mask:0xf bank_mask:0xf
    s_nop 1
    v_max_f32_dpp v92, v92, v92 row_half_mirror row_mask:0xf bank_mask:0xf
    v_sub_f32 v88, v88, v92
HOP_209:
    s_cbranch_execz HOP_210
    v_mul_f32 v88, s13, v88
    v_exp_f32 v88, v88
    s_nop 0
    v_mul_f32 v93, v88, v89
    s_nop 1
    v_add_f32_dpp v93, v93, v93 quad_perm:[1,0,3,2] row_mask:0xf bank_mask:0xf
    s_nop 1
    v_add_f32_dpp v93, v93, v93 quad_perm:[2,3,0,1] row_mask:0xf bank_mask:0xf
    s_nop 1
    v_add_f32_dpp v93, v93, v93 row_half_mirror row_mask:0xf bank_mask:0xf
    v_rcp_f32 v93, v93
    s_nop 0
HOP_210:
    s_cbranch_execz HOP_211
    v_mul_f32 v88, v88, v93
    ds_write_b32 v132, v88 offset:128
    ds_write_b32 v2, v7 offset:48
    s_mov_b32 s15, 524288
PL_69:
    ds_read_b32 v8, v2 offset:12
    s_sub_u32 s15, s15, 1
    s_cbranch_scc1 PO_70
    s_waitcnt lgkmcnt(0)
    v_readfirstlane_b32 s11, v8
    s_cmp_ge_u32 s11, 16
    s_cbranch_scc1 PO_70
HOP_211:
    s_cbranch_execz HOP_212
    s_sleep 2
    s_branch PL_69
PO_70:
    ds_read_b128 v[84:87], v149 offset:10240
    s_waitcnt lgkmcnt(0)
    buffer_store_dwordx4 v[84:87], v139, s[52:55], s26 offen sc1
    s_lshl_b32 s66, s74, 12
    s_lshl_b32 s11, s4, 9
    s_add_u32 s66, s66, s11
    s_add_u32 s66, s66, 1048576
    s_cmp_ge_u32 s63, 18
    s_cselect_b32 s11, 18, 0
HOP_212:
    s_cbranch_execz HOP_213
    s_cselect_b32 s12, 256, 0
    s_sub_u32 s11, s63, s11
    s_lshr_b32 s13, s11, 1
    s_lshl_b32 s13, s13, 12
    s_and_b32 s11, s11, 1
    s_lshl_b32 s11, s11, 7
    s_add_u32 s64, s11, s12
    s_add_u32 s64, s64, s13
    s_add_u32 s64, s64, 1048576
    v_lshrrev_b32 v136, 3, v0
    v_lshlrev_b32 v136, 9, v136
    v_and_b32 v137, 7, v0
HOP_213:
    s_cbranch_execz HOP_214
    v_lshl_add_u32 v136, v137, 4, v136
    v_add_u32 v137, 142336, v149
    v_and_b32 v133, 31, v0
    v_mul_u32_u24 v133, 48, v133
    v_lshlrev_b32 v135, 1, v0
    s_lshl_b32 s67, s63, 6
    v_and_b32 v160, 7, v0
    v_lshlrev_b32 v160, 2, v160
    v_lshrrev_b32 v9, 4, v0
    v_add_u32 v160, v9, v160
    v_mul_u32_u24 v160, 48, v160
    s_lshl_b32 s11, s72, 2
    v_add_u32 v160, s11, v160
HOP_214:
    s_cbranch_execz HOP_215
    s_mul_i32 s37, s63, 18432
    s_lshl_b32 s11, s72, 11
    s_add_u32 s37, s37, s11
    s_add_u32 s37, s37, 1114112
    s_mov_b32 s56, s34
    s_and_b32 s57, s35, 0xffff
    s_mov_b32 s58, 2304
    s_mov_b32 s59, 0x20000
    s_mov_b32 exec_hi, 0
    s_barrier
HOP_215:
    s_cbranch_execz HOP_216
    ds_read_b128 v[16:19], v137 offset:0
    ds_read_b128 v[20:23], v137 offset:512
    ds_read_b128 v[24:27], v137 offset:1024
    ds_read_b128 v[28:31], v137 offset:1536
    ds_read_b128 v[32:35], v137 offset:2048
    ds_read_b128 v[36:39], v137 offset:2560
    ds_read_b128 v[40:43], v137 offset:3072
HOP_216:
    s_cbranch_execz HOP_217
    ds_read_b128 v[44:47], v137 offset:3584
    s_waitcnt lgkmcnt(6)
    v_pk_add_f32 v[16:17], v[16:17], v[20:21]
    v_pk_add_f32 v[18:19], v[18:19], v[22:23]
    s_waitcnt lgkmcnt(5)
    v_pk_add_f32 v[16:17], v[16:17], v[24:25]
    v_pk_add_f32 v[18:19], v[18:19], v[26:27]
    s_waitcnt lgkmcnt(4)
    v_pk_add_f32 v[16:17], v[16:17], v[28:29]
HOP_217:
    s_cbranch_execz HOP_218
    v_pk_add_f32 v[18:19], v[18:19], v[30:31]
    s_waitcnt lgkmcnt(3)
    v_pk_add_f32 v[16:17], v[16:17], v[32:33]
    v_pk_add_f32 v[18:19], v[18:19], v[34:35]
    s_waitcnt lgkmcnt(2)
    v_pk_add_f32 v[16:17], v[16:17], v[36:37]
    v_pk_add_f32 v[18:19], v[18:19], v[38:39]
    s_waitcnt lgkmcnt(1)
    v_pk_add_f32 v[16:17], v[16:17], v[40:41]
HOP_218:
    s_cbranch_execz HOP_219
    v_pk_add_f32 v[18:19], v[18:19], v[42:43]
    s_waitcnt lgkmcnt(0)
    v_pk_add_f32 v[16:17], v[16:17], v[44:45]
    v_pk_add_f32 v[18:19], v[18:19], v[46:47]
    v_add_u32 v16, 0x80, v16
    v_add_u32 v17, 0x80, v17
    v_add_u32 v18, 0x80, v18
    v_add_u32 v19, 0x80, v19
HOP_219:
    s_cbranch_execz HOP_220
    v_bfi_b32 v16, v3, s6, v16
    v_bfi_b32 v17, v3, s7, v17
    v_bfi_b32 v18, v3, s8, v18
    v_bfi_b32 v19, v3, s9, v19
    buffer_store_dwordx4 v[16:19], v149, s[52:55], s66 offen sc1
    s_mov_b64 exec, -1
    s_cmp_ge_u32 s63, 36
    s_cbranch_scc1 L_END
    v_mov_b32 v138, 2
HOP_220:
    s_cbranch_execz HOP_221
    s_mov_b32 s15, 32768
MG_71:
    buffer_load_dwordx4 v[80:83], v136, s[52:55], s64 offen sc1
MC_72:
    s_waitcnt vmcnt(0)
    v_xor_b32 v80, s6, v80
    v_xor_b32 v81, s7, v81
    v_xor_b32 v82, s8, v82
    v_xor_b32 v83, s9, v83
    v_or3_b32 v9, v80, v81, v82
    v_or_b32 v9, v9, v83
    v_mov_b32 v88, v80
    v_mov_b32 v89, v81
    v_mov_b32 v90, v82
HOP_221:
    s_cbranch_execz HOP_222
    v_mov_b32 v91, v83
    v_and_b32 v9, v3, v9
    v_cmp_ne_u32 vcc, 0, v9
    s_cbranch_vccz MD_73
    s_sub_u32 s15, s15, 1
    s_cbranch_scc1 MD_73
    s_sleep 2
    s_branch MG_71
MD_73:
    v_permlane32_swap_b32 v88, v90
    v_permlane32_swap_b32 v89, v91
    v_pk_add_f32 v[88:89], v[88:89], v[90:91]
    s_nop 1
    v_permlane16_swap_b32 v88, v89
    v_add_f32 v88, v88, v89
HOP_222:
    s_cbranch_execz HOP_223
    s_nop 1
    v_add_f32_dpp v88, v88, v88 row_ror:8 row_mask:0xf bank_mask:0xf
    ds_write_b32 v160, v88 offset:8452
    s_waitcnt lgkmcnt(0)
    ds_write_b32 v2, v138 offset:48
    ds_read_b32 v134, v133 offset:8484
    s_waitcnt lgkmcnt(0)
    v_cvt_pk_bf16_f32 v134, v134, v134
    v_lshlrev_b32 v134, 16, v134
    v_add_f32 v134, v134, v128
HOP_223:
    s_cbranch_execz HOP_224
    v_cvt_pk_bf16_f32 v128, v134, v134
    v_lshlrev_b32 v128, 16, v128
    s_cmp_lg_u32 s63, 0
    s_cbranch_scc1 L_NOEP
    s_add_u32 s11, s10, 1
    v_mov_b32 v134, s11
    s_mov_b64 exec, 1
    buffer_store_dword v134, v2, s[52:55], 0 offen sc1
    s_mov_b64 exec, -1
L_NOEP:
    s_mov_b32 s15, 32768
MG_74:
    buffer_load_dwordx4 v[80:83], v149, s[52:55], s37 offen sc1
HOP_224:
    s_cbranch_execz HOP_225
    buffer_load_dwordx4 v[84:87], v149, s[52:55], s37 offen offset:1024 sc1
MC_75:
    s_waitcnt vmcnt(1)
    v_xor_b32 v80, s6, v80
    v_xor_b32 v81, s7, v81
    v_xor_b32 v82, s8, v82
    v_xor_b32 v83, s9, v83
    v_or3_b32 v9, v80, v81, v82
    v_or_b32 v9, v9, v83
    s_waitcnt vmcnt(0)
    v_xor_b32 v84, s6, v84
    v_xor_b32 v85, s7, v85
    v_xor_b32 v86, s8, v86
    v_xor_b32 v87, s9, v87
HOP_225:
    s_cbranch_execz HOP_226
    v_or3_b32 v9, v9, v84, v85
    v_or3_b32 v9, v9, v86, v87
    v_pk_add_f32 v[88:89], v[80:81], v[84:85]
    v_pk_add_f32 v[90:91], v[82:83], v[86:87]
    v_and_b32 v9, v3, v9
    v_cmp_ne_u32 vcc, 0, v9
    s_cbranch_vccz MD_76
    s_sub_u32 s15, s15, 1
    s_cbranch_scc1 MD_76
    s_branch MG_74
MD_76:
    v_permlane32_swap_b32 v88, v90
HOP_226:
    s_cbranch_execz HOP_227
    v_permlane32_swap_b32 v89, v91
    v_pk_add_f32 v[88:89], v[88:89], v[90:91]
    s_nop 1
    v_permlane16_swap_b32 v88, v89
    v_add_f32 v88, v88, v89
    s_nop 1
    v_add_f32_dpp v88, v88, v88 row_ror:8 row_mask:0xf bank_mask:0xf
    ds_write_b32 v160, v88 offset:8448
    s_waitcnt lgkmcnt(0)
    s_mov_b32 exec_hi, 0
    s_barrier
HOP_227:
    s_cbranch_execz HOP_228
    ds_read_b128 v[16:19], v133 offset:8448
    ds_read_b128 v[20:23], v133 offset:8464
    ds_read_b32 v134, v133 offset:8480
    s_waitcnt lgkmcnt(1)
    v_pk_add_f32 v[16:17], v[16:17], v[18:19]
    v_pk_add_f32 v[20:21], v[20:21], v[22:23]
    v_pk_add_f32 v[16:17], v[16:17], v[20:21]
    s_waitcnt lgkmcnt(0)
    v_add_f32 v134, v134, v16
HOP_228:
    s_cbranch_execz HOP_229
    v_add_f32 v134, v134, v17
    v_cvt_pk_bf16_f32 v134, v134, v134
    v_lshlrev_b32 v134, 16, v134
    v_add_f32 v134, v134, v128
    v_cvt_pk_bf16_f32 v134, v134, v134
    buffer_store_short v134, v135, s[56:59], s67 offen
    s_mov_b64 exec, -1
    s_endpgm
HOP_229:
    s_cbranch_execz L_RESUME
    s_nop 0
L_END:
L_EXIT:
    s_endpgm
L_CODE_END:
.section .rodata,"a"
.p2align 6
.amdhsa_kernel sequential_preLN__sliding_block_cached__glu_gated_swiglu__decode_kernel
  .amdhsa_next_free_vgpr 168
  .amdhsa_next_free_sgpr 78
  .amdhsa_accum_offset 168
  .amdhsa_group_segment_fixed_size 0
  .amdhsa_kernarg_size 96
  .amdhsa_user_sgpr_count 2
  .amdhsa_user_sgpr_kernarg_segment_ptr 1
  .amdhsa_system_sgpr_workgroup_id_x 1
.end_amdhsa_kernel
```
